```python
import torch

def _softmax(x, axis=-1):
    return torch.softmax(x, dim=axis)
def _gelu(x):
    return torch.nn.functional.gelu(x, approximate="tanh")
def _silu(x):
    return torch.nn.functional.silu(x)
def _sigmoid(x):
    return torch.sigmoid(x)
def _layernorm(x, axis=-1, eps=1e-5):
    m = x.mean(dim=axis, keepdim=True)
    v = x.var(dim=axis, keepdim=True, unbiased=False)
    return (x - m) / torch.sqrt(v + eps)
def _scatter_add(tgt, idx, src, axis=0):
    return tgt.clone().index_add_(axis, idx, src)
def _segment_sum(src, seg, n):
    out = torch.zeros((n,) + src.shape[1:], dtype=src.dtype)
    return out.index_add_(0, seg, src)
def _pad(x, pw):
    flat = tuple(v for pair in reversed(pw) for v in pair)
    return torch.nn.functional.pad(x, flat)

kernel_name = 'standalone__kv_cache_quant_int4_int2_kv_with_per_channel_or_per_token_scales__decode'

def setup_inputs():

    _w = (lambda a: (lambda t: t.to(torch.bfloat16) if t.is_floating_point() else t)(torch.as_tensor(a)))
    B = 1
    Sq = 1
    Skv = 65536
    Hq = 32
    Hkv = 16
    Dh = 128
    bits = 4
    G = -1
    if G <= 0 or G >= Skv:
        G = max(1, Skv // 2)
    Skv = (Skv // G) * G
    ngk = Skv // G
    qmax = (1 << bits) - 1
    return {
        "q": _w((lambda *s: torch.randn(*s, dtype=torch.bfloat16) * 1.6)(B, Hq, Sq, Dh)),
        "qk": _w(torch.randint(0, qmax + 1, (B, Hkv, Skv, Dh)).to(torch.int32)),
        "qv": _w(torch.randint(0, qmax + 1, (B, Hkv, Skv, Dh)).to(torch.int32)),
        "k_scales": _w(torch.abs((lambda *s: torch.randn(*s, dtype=torch.bfloat16) * 1.6)(B, Hkv, ngk, Dh)) * 0.05 + 0.02),
        "k_zeros": _w((lambda *s: torch.randn(*s, dtype=torch.bfloat16) * 1.6)(B, Hkv, ngk, Dh) + float(qmax) / 2.0),
        "v_scales": _w(torch.abs((lambda *s: torch.randn(*s, dtype=torch.bfloat16) * 0.05)(B, Hkv, Skv, 1)) * 0.05 + 0.02),
        "v_zeros": _w((lambda *s: torch.randn(*s, dtype=torch.bfloat16) * 0.05)(B, Hkv, Skv, 1) + float(qmax) / 2.0),
    }

def reference(q, qk, qv, k_scales, k_zeros, v_scales, v_zeros):
    B, Hq, Sq, Dh = q.shape
    Hkv, Skv = qk.shape[1], qk.shape[2]
    ngk = k_scales.shape[2]
    G = Skv // ngk
    ks = (lambda x, n, axis: torch.repeat_interleave(x, n, dim=axis))(k_scales, G, axis=2)
    kz = (lambda x, n, axis: torch.repeat_interleave(x, n, dim=axis))(k_zeros, G, axis=2)
    k = ((lambda x, dt: x.to(dt))(qk, q.dtype) - kz) * ks
    v = ((lambda x, dt: x.to(dt))(qv, q.dtype) - v_zeros) * v_scales
    rep = Hq // Hkv
    if rep > 1:
        k = (lambda x, n, axis: torch.repeat_interleave(x, n, dim=axis))(k, rep, axis=1)
        v = (lambda x, n, axis: torch.repeat_interleave(x, n, dim=axis))(v, rep, axis=1)
    scale = float(Dh) ** -0.5
    logits = torch.einsum("bhqd,bhkd->bhqk", q, k) * scale
    p = _softmax(logits, axis=-1)
    o = torch.einsum("bhqk,bhkd->bhqd", p, v)
    return o
```

```asm
; @launch grid=(256,1,1) block=(512,1,1) lds=28928
.amdgcn_target "amdgcn-amd-amdhsa--gfx950"
.text
.globl standalone__kv_cache_quant_int4_int2_kv_with_per_channel_or_per_token_scales__decode_kernel
.p2align 8
.type standalone__kv_cache_quant_int4_int2_kv_with_per_channel_or_per_token_scales__decode_kernel,@function
standalone__kv_cache_quant_int4_int2_kv_with_per_channel_or_per_token_scales__decode_kernel:
  s_cmp_ge_u32 s2, 256
  s_cbranch_scc1 L_main_end
  s_load_dwordx8 s[4:11], s[0:1], 0
  s_load_dwordx4 s[12:15], s[0:1], 32
  s_load_dwordx2 s[16:17], s[0:1], 48
  s_load_dwordx4 s[20:23], s[0:1], 64
  s_load_dwordx2 s[90:91], s[0:1], 56
  v_lshrrev_b32 v4, 6, v0
  v_and_b32 v0, 63, v0
  v_readfirstlane_b32 s3, v4
  s_lshr_b32 s24, s2, 3
  s_and_b32 s25, s2, 7
  s_lshr_b32 s26, s2, 4
  s_and_b32 s27, s2, 8
  s_lshl_b32 s27, s27, 7
  s_add_u32 s27, s27, s3
  s_lshl_b32 s83, s2, 11
  s_lshl_b32 s18, s26, 25
  s_lshl_b32 s19, s26, 17
  v_lshrrev_b32 v4, 4, v0
  v_bfe_u32 v5, v0, 2, 2
  v_and_b32 v6, 3, v0
  v_and_b32 v7, 15, v0
  v_lshlrev_b32 v1, 12, v5
  v_lshl_add_u32 v1, v4, 6, v1
  v_lshl_add_u32 v1, v6, 4, v1
  v_lshlrev_b32 v2, 12, v4
  v_lshl_add_u32 v2, v7, 4, v2
  v_lshlrev_b32 v3, 4, v4
  v_bfe_u32 v8, v0, 2, 1
  v_lshlrev_b32 v9, 5, v4
  v_lshl_add_u32 v9, v6, 3, v9
  s_lshl_b32 s28, s26, 9
  v_lshl_add_u32 v10, v8, 8, v9
  v_add_u32 v10, s28, v10
  s_lshr_b32 s28, s2, 3
  s_lshl_b32 s28, s28, 8
  v_add_u32 v11, s28, v9
  v_mov_b32 v126, 0
  v_mov_b32 v127, 0
  s_lshr_b32 s72, s25, 3
  s_lshl_b32 s72, s72, 1
  s_add_u32 s72, s72, s26
  s_and_b32 s72, s72, 15
  s_lshl_b32 s72, s72, 3
  s_and_b32 s73, s25, 7
  s_lshl_b32 s73, s73, 7
  s_add_u32 s72, s72, s73
  s_add_u32 s72, s72, s27
  s_lshl_b32 s72, s72, 14
  s_cmp_eq_u32 s25, 0
  s_cselect_b32 s74, 1, 0
  s_cmp_eq_u32 s3, 0
  s_cselect_b32 s80, 1, 0
  s_and_b32 s81, s74, s80
  s_waitcnt lgkmcnt(0)
  s_mov_b32 s32, s4
  s_mov_b32 s33, s5
  s_mov_b32 s34, 8192
  s_mov_b32 s35, 0x00020000
  s_mov_b32 s44, s10
  s_mov_b32 s45, s11
  s_mov_b32 s46, 8192
  s_mov_b32 s47, 0x00020000
  s_mov_b32 s48, s12
  s_mov_b32 s49, s13
  s_mov_b32 s50, 8192
  s_mov_b32 s51, 0x00020000
  s_add_u32 s36, s6, s18
  s_addc_u32 s37, s7, 0
  s_mov_b32 s38, 33554432
  s_mov_b32 s39, 0x00020000
  buffer_load_dwordx2 v[4:5], v10, s[32:35], 0 offen
  buffer_load_dwordx2 v[6:7], v10, s[32:35], 0 offen offset:128
  buffer_load_dwordx2 v[48:49], v11, s[48:51], 0 offen
  buffer_load_dwordx2 v[50:51], v11, s[48:51], 0 offen offset:128
  buffer_load_dwordx2 v[52:53], v11, s[44:47], 0 offen
  buffer_load_dwordx2 v[54:55], v11, s[44:47], 0 offen offset:128
  buffer_load_dwordx4 v[128:131], v1, s[36:39], s72 offen offset:0 nt
  buffer_load_dwordx4 v[132:135], v1, s[36:39], s72 offen offset:256 nt
  buffer_load_dwordx4 v[136:139], v1, s[36:39], s72 offen offset:512 nt
  buffer_load_dwordx4 v[140:143], v1, s[36:39], s72 offen offset:768 nt
  buffer_load_dwordx4 v[144:147], v1, s[36:39], s72 offen offset:1024 nt
  buffer_load_dwordx4 v[148:151], v1, s[36:39], s72 offen offset:1280 nt
  buffer_load_dwordx4 v[152:155], v1, s[36:39], s72 offen offset:1536 nt
  buffer_load_dwordx4 v[156:159], v1, s[36:39], s72 offen offset:1792 nt
  buffer_load_dwordx4 v[160:163], v1, s[36:39], s72 offen offset:2048 nt
  buffer_load_dwordx4 v[164:167], v1, s[36:39], s72 offen offset:2304 nt
  buffer_load_dwordx4 v[168:171], v1, s[36:39], s72 offen offset:2560 nt
  buffer_load_dwordx4 v[172:175], v1, s[36:39], s72 offen offset:2816 nt
  buffer_load_dwordx4 v[176:179], v1, s[36:39], s72 offen offset:3072 nt
  buffer_load_dwordx4 v[180:183], v1, s[36:39], s72 offen offset:3328 nt
  buffer_load_dwordx4 v[184:187], v1, s[36:39], s72 offen offset:3584 nt
  buffer_load_dwordx4 v[188:191], v1, s[36:39], s72 offen offset:3840 nt
  s_add_u32 s40, s8, s18
  s_addc_u32 s41, s9, 0
  s_mov_b32 s42, 33554432
  s_mov_b32 s43, 0x00020000
  s_add_u32 s52, s14, s19
  s_addc_u32 s53, s15, 0
  s_mov_b32 s54, 131072
  s_mov_b32 s55, 0x00020000
  s_add_u32 s56, s16, s19
  s_addc_u32 s57, s17, 0
  s_mov_b32 s58, 131072
  s_mov_b32 s59, 0x00020000
  s_mov_b32 s60, s22
  s_mov_b32 s61, s23
  s_mov_b32 s62, 6291456
  s_mov_b32 s63, 0x00020000
  s_mov_b32 s76, s20
  s_mov_b32 s77, s21
  s_mov_b32 s78, 256
  s_mov_b32 s79, 0x00020000
  s_mov_b32 s92, s90
  s_mov_b32 s93, s91
  s_mov_b32 s94, 8192
  s_mov_b32 s95, 0x00020000
  s_lshl_b32 s6, s24, 8
  s_add_u32 s6, s6, 4194304
  s_add_u32 s9, s6, 4
  s_mov_b32 s7, s24
  s_mov_b32 s8, -1
  s_cmp_eq_u32 s80, 0
  s_cbranch_scc1 L_noinit
  v_lshl_add_u32 v118, v0, 3, s25
  v_lshlrev_b32 v119, 2, v0
  s_mov_b64 exec, 63
  ds_write_b32 v119, v118 offset:28672
  s_mov_b64 exec, -1
  s_cmp_eq_u32 s81, 0
  s_cbranch_scc1 L_noinit
  s_mov_b64 exec, 1
  buffer_store_dwordx2 v[126:127], off, s[60:63], s6 sc1
  s_mov_b64 exec, -1
L_noinit:
  v_mov_b32 v84, 0
  v_mov_b32 v85, 0
  v_mov_b32 v86, 0
  v_mov_b32 v87, 0
  v_mov_b32 v88, 0
  v_mov_b32 v89, 0
  v_mov_b32 v90, 0
  v_mov_b32 v91, 0
  v_mov_b32 v92, 0
  v_mov_b32 v93, 0
  v_mov_b32 v94, 0
  v_mov_b32 v95, 0
  v_mov_b32 v96, 0
  v_mov_b32 v97, 0
  v_mov_b32 v98, 0
  v_mov_b32 v99, 0
  v_mov_b32 v100, 0
  v_mov_b32 v101, 0
  v_mov_b32 v102, 0
  v_mov_b32 v103, 0
  v_mov_b32 v104, 0
  v_mov_b32 v105, 0
  v_mov_b32 v106, 0
  v_mov_b32 v107, 0
  v_mov_b32 v108, 0
  v_mov_b32 v109, 0
  v_mov_b32 v110, 0
  v_mov_b32 v111, 0
  v_mov_b32 v112, 0
  v_mov_b32 v113, 0
  v_mov_b32 v114, 0
  v_mov_b32 v115, 0
  v_mov_b32 v116, 0xff800000
  v_mov_b32 v117, 0
  s_mov_b32 s64, 0xffff0000
  s_mov_b32 s65, 0xffff0000
  s_mov_b32 s66, 0x3fb8aa3b
  s_mov_b32 s67, 0x3db504f3
  s_mov_b32 s68, 0xffff0000
  s_mov_b32 s28, s25
  s_mov_b32 s29, 0
  s_mov_b32 s31, 28800
  s_mov_b32 s89, 0
  s_mov_b32 s30, 1
  s_lshr_b32 s82, s3, 1
  s_lshl_b32 s82, 1, s82
  s_add_u32 s32, s72, 0x20000
  s_and_b32 s32, s32, 0x1e0000
  s_andn2_b32 s73, s72, 0x1e0000
  s_or_b32 s32, s32, s73
  s_mov_b32 s33, 0
  s_mov_b32 s34, 0
  s_mul_i32 s48, s3, 3584
  s_mov_b32 s49, s48
  s_mov_b32 s50, 0x00110011
  s_mov_b32 s51, 0x00110011
  s_waitcnt vmcnt(16)
  v_lshlrev_b32 v8, 16, v48
  v_and_b32 v9, s68, v48
  v_and_b32 v16, 0xffff, v52
  v_and_b32 v17, s68, v52
  v_lshlrev_b32 v10, 16, v49
  v_and_b32 v11, s68, v49
  v_and_b32 v18, 0xffff, v53
  v_and_b32 v19, s68, v53
  v_lshlrev_b32 v12, 16, v50
  v_and_b32 v13, s68, v50
  v_and_b32 v20, 0xffff, v54
  v_and_b32 v21, s68, v54
  v_lshlrev_b32 v14, 16, v51
  v_and_b32 v15, s68, v51
  v_and_b32 v22, 0xffff, v55
  v_and_b32 v23, s68, v55
.p2align 6
L_A:
  s_waitcnt vmcnt(14)
  v_cvt_f32_i32 v128, v128
  v_cvt_f32_i32 v129, v129
  v_cvt_f32_i32 v130, v130
  v_cvt_f32_i32 v131, v131
  v_cvt_f32_i32 v132, v132
  v_cvt_f32_i32 v133, v133
  v_cvt_f32_i32 v134, v134
  v_cvt_f32_i32 v135, v135
  v_pk_add_f32 v[128:129], v[128:129], v[8:9] neg_lo:[0,1] neg_hi:[0,1]
  v_pk_add_f32 v[130:131], v[130:131], v[10:11] neg_lo:[0,1] neg_hi:[0,1]
  v_pk_add_f32 v[132:133], v[132:133], v[12:13] neg_lo:[0,1] neg_hi:[0,1]
  v_pk_add_f32 v[134:135], v[134:135], v[14:15] neg_lo:[0,1] neg_hi:[0,1]
  v_cvt_pk_bf16_f32 v48, v128, v129
  v_cvt_pk_bf16_f32 v49, v130, v131
  v_cvt_pk_bf16_f32 v50, v132, v133
  v_cvt_pk_bf16_f32 v51, v134, v135
  buffer_load_dwordx4 v[192:195], v1, s[36:39], s32 offen offset:0 nt
  buffer_load_dwordx4 v[196:199], v1, s[36:39], s32 offen offset:256 nt
  v_dot2_f32_bf16 v52, v48, v16, 0
  v_dot2_f32_bf16 v53, v48, v17, 0
  v_dot2_f32_bf16 v54, v49, v18, 0
  v_dot2_f32_bf16 v55, v49, v19, 0
  v_dot2_f32_bf16 v56, v50, v20, 0
  v_dot2_f32_bf16 v57, v50, v21, 0
  v_dot2_f32_bf16 v58, v51, v22, 0
  v_dot2_f32_bf16 v59, v51, v23, 0
  v_cvt_pk_bf16_f32 v60, v52, v53
  v_cvt_pk_bf16_f32 v61, v54, v55
  v_cvt_pk_bf16_f32 v62, v56, v57
  v_cvt_pk_bf16_f32 v63, v58, v59
  s_nop 1
  v_mfma_f32_16x16x32_bf16 v[64:67], v[60:63], v[4:7], 0
  s_waitcnt vmcnt(14)
  v_cvt_f32_i32 v136, v136
  v_cvt_f32_i32 v137, v137
  v_cvt_f32_i32 v138, v138
  v_cvt_f32_i32 v139, v139
  v_cvt_f32_i32 v140, v140
  v_cvt_f32_i32 v141, v141
  v_cvt_f32_i32 v142, v142
  v_cvt_f32_i32 v143, v143
  v_pk_add_f32 v[136:137], v[136:137], v[8:9] neg_lo:[0,1] neg_hi:[0,1]
  v_pk_add_f32 v[138:139], v[138:139], v[10:11] neg_lo:[0,1] neg_hi:[0,1]
  v_pk_add_f32 v[140:141], v[140:141], v[12:13] neg_lo:[0,1] neg_hi:[0,1]
  v_pk_add_f32 v[142:143], v[142:143], v[14:15] neg_lo:[0,1] neg_hi:[0,1]
  v_cvt_pk_bf16_f32 v48, v136, v137
  v_cvt_pk_bf16_f32 v49, v138, v139
  v_cvt_pk_bf16_f32 v50, v140, v141
  v_cvt_pk_bf16_f32 v51, v142, v143
  buffer_load_dwordx4 v[200:203], v1, s[36:39], s32 offen offset:512 nt
  buffer_load_dwordx4 v[204:207], v1, s[36:39], s32 offen offset:768 nt
  v_mov_b32_dpp v120, v64 quad_perm:[0,0,0,0] row_mask:0xf bank_mask:0xf
  v_mov_b32_dpp v121, v66 quad_perm:[2,2,2,2] row_mask:0xf bank_mask:0xf
  v_dot2_f32_bf16 v52, v48, v16, 0
  v_dot2_f32_bf16 v53, v48, v17, 0
  v_add_f32_dpp v120, v65, v120 quad_perm:[1,1,1,1] row_mask:0xf bank_mask:0xf
  v_add_f32_dpp v121, v67, v121 quad_perm:[3,3,3,3] row_mask:0xf bank_mask:0xf
  v_dot2_f32_bf16 v54, v49, v18, 0
  v_dot2_f32_bf16 v55, v49, v19, 0
  v_add_f32 v72, v120, v121
  v_dot2_f32_bf16 v56, v50, v20, 0
  v_dot2_f32_bf16 v57, v50, v21, 0
  v_dot2_f32_bf16 v58, v51, v22, 0
  v_dot2_f32_bf16 v59, v51, v23, 0
  v_cvt_pk_bf16_f32 v60, v52, v53
  v_cvt_pk_bf16_f32 v61, v54, v55
  v_cvt_pk_bf16_f32 v62, v56, v57
  v_cvt_pk_bf16_f32 v63, v58, v59
  s_nop 1
  v_mfma_f32_16x16x32_bf16 v[68:71], v[60:63], v[4:7], 0
  s_waitcnt vmcnt(14)
  v_cvt_f32_i32 v144, v144
  v_cvt_f32_i32 v145, v145
  v_cvt_f32_i32 v146, v146
  v_cvt_f32_i32 v147, v147
  v_cvt_f32_i32 v148, v148
  v_cvt_f32_i32 v149, v149
  v_cvt_f32_i32 v150, v150
  v_cvt_f32_i32 v151, v151
  v_pk_add_f32 v[144:145], v[144:145], v[8:9] neg_lo:[0,1] neg_hi:[0,1]
  v_pk_add_f32 v[146:147], v[146:147], v[10:11] neg_lo:[0,1] neg_hi:[0,1]
  v_pk_add_f32 v[148:149], v[148:149], v[12:13] neg_lo:[0,1] neg_hi:[0,1]
  v_pk_add_f32 v[150:151], v[150:151], v[14:15] neg_lo:[0,1] neg_hi:[0,1]
  v_cvt_pk_bf16_f32 v48, v144, v145
  v_cvt_pk_bf16_f32 v49, v146, v147
  v_cvt_pk_bf16_f32 v50, v148, v149
  v_cvt_pk_bf16_f32 v51, v150, v151
  buffer_load_dwordx4 v[208:211], v1, s[36:39], s32 offen offset:1024 nt
  buffer_load_dwordx4 v[212:215], v1, s[36:39], s32 offen offset:1280 nt
  v_mov_b32_dpp v120, v68 quad_perm:[0,0,0,0] row_mask:0xf bank_mask:0xf
  v_mov_b32_dpp v121, v70 quad_perm:[2,2,2,2] row_mask:0xf bank_mask:0xf
  v_dot2_f32_bf16 v52, v48, v16, 0
  v_dot2_f32_bf16 v53, v48, v17, 0
  v_add_f32_dpp v120, v69, v120 quad_perm:[1,1,1,1] row_mask:0xf bank_mask:0xf
  v_add_f32_dpp v121, v71, v121 quad_perm:[3,3,3,3] row_mask:0xf bank_mask:0xf
  v_dot2_f32_bf16 v54, v49, v18, 0
  v_dot2_f32_bf16 v55, v49, v19, 0
  v_add_f32 v73, v120, v121
  v_dot2_f32_bf16 v56, v50, v20, 0
  v_dot2_f32_bf16 v57, v50, v21, 0
  v_dot2_f32_bf16 v58, v51, v22, 0
  v_dot2_f32_bf16 v59, v51, v23, 0
  v_cvt_pk_bf16_f32 v60, v52, v53
  v_cvt_pk_bf16_f32 v61, v54, v55
  v_cvt_pk_bf16_f32 v62, v56, v57
  v_cvt_pk_bf16_f32 v63, v58, v59
  s_nop 1
  v_mfma_f32_16x16x32_bf16 v[64:67], v[60:63], v[4:7], 0
  s_waitcnt vmcnt(14)
  v_cvt_f32_i32 v152, v152
  v_cvt_f32_i32 v153, v153
  v_cvt_f32_i32 v154, v154
  v_cvt_f32_i32 v155, v155
  v_cvt_f32_i32 v156, v156
  v_cvt_f32_i32 v157, v157
  v_cvt_f32_i32 v158, v158
  v_cvt_f32_i32 v159, v159
  v_pk_add_f32 v[152:153], v[152:153], v[8:9] neg_lo:[0,1] neg_hi:[0,1]
  v_pk_add_f32 v[154:155], v[154:155], v[10:11] neg_lo:[0,1] neg_hi:[0,1]
  v_pk_add_f32 v[156:157], v[156:157], v[12:13] neg_lo:[0,1] neg_hi:[0,1]
  v_pk_add_f32 v[158:159], v[158:159], v[14:15] neg_lo:[0,1] neg_hi:[0,1]
  v_cvt_pk_bf16_f32 v48, v152, v153
  v_cvt_pk_bf16_f32 v49, v154, v155
  v_cvt_pk_bf16_f32 v50, v156, v157
  v_cvt_pk_bf16_f32 v51, v158, v159
  buffer_load_dwordx4 v[216:219], v1, s[36:39], s32 offen offset:1536 nt
  buffer_load_dwordx4 v[220:223], v1, s[36:39], s32 offen offset:1792 nt
  v_mov_b32_dpp v120, v64 quad_perm:[0,0,0,0] row_mask:0xf bank_mask:0xf
  v_mov_b32_dpp v121, v66 quad_perm:[2,2,2,2] row_mask:0xf bank_mask:0xf
  v_dot2_f32_bf16 v52, v48, v16, 0
  v_dot2_f32_bf16 v53, v48, v17, 0
  v_add_f32_dpp v120, v65, v120 quad_perm:[1,1,1,1] row_mask:0xf bank_mask:0xf
  v_add_f32_dpp v121, v67, v121 quad_perm:[3,3,3,3] row_mask:0xf bank_mask:0xf
  v_dot2_f32_bf16 v54, v49, v18, 0
  v_dot2_f32_bf16 v55, v49, v19, 0
  v_add_f32 v74, v120, v121
  v_dot2_f32_bf16 v56, v50, v20, 0
  v_dot2_f32_bf16 v57, v50, v21, 0
  v_dot2_f32_bf16 v58, v51, v22, 0
  v_dot2_f32_bf16 v59, v51, v23, 0
  v_cvt_pk_bf16_f32 v60, v52, v53
  v_cvt_pk_bf16_f32 v61, v54, v55
  v_cvt_pk_bf16_f32 v62, v56, v57
  v_cvt_pk_bf16_f32 v63, v58, v59
  s_nop 1
  v_mfma_f32_16x16x32_bf16 v[68:71], v[60:63], v[4:7], 0
  s_waitcnt vmcnt(14)
  v_cvt_f32_i32 v160, v160
  v_cvt_f32_i32 v161, v161
  v_cvt_f32_i32 v162, v162
  v_cvt_f32_i32 v163, v163
  v_cvt_f32_i32 v164, v164
  v_cvt_f32_i32 v165, v165
  v_cvt_f32_i32 v166, v166
  v_cvt_f32_i32 v167, v167
  v_pk_add_f32 v[160:161], v[160:161], v[8:9] neg_lo:[0,1] neg_hi:[0,1]
  v_pk_add_f32 v[162:163], v[162:163], v[10:11] neg_lo:[0,1] neg_hi:[0,1]
  v_pk_add_f32 v[164:165], v[164:165], v[12:13] neg_lo:[0,1] neg_hi:[0,1]
  v_pk_add_f32 v[166:167], v[166:167], v[14:15] neg_lo:[0,1] neg_hi:[0,1]
  v_cvt_pk_bf16_f32 v48, v160, v161
  v_cvt_pk_bf16_f32 v49, v162, v163
  v_cvt_pk_bf16_f32 v50, v164, v165
  v_cvt_pk_bf16_f32 v51, v166, v167
  buffer_load_dwordx4 v[224:227], v1, s[36:39], s32 offen offset:2048 nt
  buffer_load_dwordx4 v[228:231], v1, s[36:39], s32 offen offset:2304 nt
  v_mov_b32_dpp v120, v68 quad_perm:[0,0,0,0] row_mask:0xf bank_mask:0xf
  v_mov_b32_dpp v121, v70 quad_perm:[2,2,2,2] row_mask:0xf bank_mask:0xf
  v_dot2_f32_bf16 v52, v48, v16, 0
  v_dot2_f32_bf16 v53, v48, v17, 0
  v_add_f32_dpp v120, v69, v120 quad_perm:[1,1,1,1] row_mask:0xf bank_mask:0xf
  v_add_f32_dpp v121, v71, v121 quad_perm:[3,3,3,3] row_mask:0xf bank_mask:0xf
  v_dot2_f32_bf16 v54, v49, v18, 0
  v_dot2_f32_bf16 v55, v49, v19, 0
  v_add_f32 v75, v120, v121
  v_dot2_f32_bf16 v56, v50, v20, 0
  v_dot2_f32_bf16 v57, v50, v21, 0
  v_dot2_f32_bf16 v58, v51, v22, 0
  v_dot2_f32_bf16 v59, v51, v23, 0
  v_cvt_pk_bf16_f32 v60, v52, v53
  v_cvt_pk_bf16_f32 v61, v54, v55
  v_cvt_pk_bf16_f32 v62, v56, v57
  v_cvt_pk_bf16_f32 v63, v58, v59
  s_nop 1
  v_mfma_f32_16x16x32_bf16 v[64:67], v[60:63], v[4:7], 0
  s_waitcnt vmcnt(14)
  v_cvt_f32_i32 v168, v168
  v_cvt_f32_i32 v169, v169
  v_cvt_f32_i32 v170, v170
  v_cvt_f32_i32 v171, v171
  v_cvt_f32_i32 v172, v172
  v_cvt_f32_i32 v173, v173
  v_cvt_f32_i32 v174, v174
  v_cvt_f32_i32 v175, v175
  v_pk_add_f32 v[168:169], v[168:169], v[8:9] neg_lo:[0,1] neg_hi:[0,1]
  v_pk_add_f32 v[170:171], v[170:171], v[10:11] neg_lo:[0,1] neg_hi:[0,1]
  v_pk_add_f32 v[172:173], v[172:173], v[12:13] neg_lo:[0,1] neg_hi:[0,1]
  v_pk_add_f32 v[174:175], v[174:175], v[14:15] neg_lo:[0,1] neg_hi:[0,1]
  v_cvt_pk_bf16_f32 v48, v168, v169
  v_cvt_pk_bf16_f32 v49, v170, v171
  v_cvt_pk_bf16_f32 v50, v172, v173
  v_cvt_pk_bf16_f32 v51, v174, v175
  buffer_load_dwordx4 v[232:235], v1, s[36:39], s32 offen offset:2560 nt
  buffer_load_dwordx4 v[236:239], v1, s[36:39], s32 offen offset:2816 nt
  v_mov_b32_dpp v120, v64 quad_perm:[0,0,0,0] row_mask:0xf bank_mask:0xf
  v_mov_b32_dpp v121, v66 quad_perm:[2,2,2,2] row_mask:0xf bank_mask:0xf
  v_dot2_f32_bf16 v52, v48, v16, 0
  v_dot2_f32_bf16 v53, v48, v17, 0
  v_add_f32_dpp v120, v65, v120 quad_perm:[1,1,1,1] row_mask:0xf bank_mask:0xf
  v_add_f32_dpp v121, v67, v121 quad_perm:[3,3,3,3] row_mask:0xf bank_mask:0xf
  v_dot2_f32_bf16 v54, v49, v18, 0
  v_dot2_f32_bf16 v55, v49, v19, 0
  v_add_f32 v76, v120, v121
  v_dot2_f32_bf16 v56, v50, v20, 0
  v_dot2_f32_bf16 v57, v50, v21, 0
  v_dot2_f32_bf16 v58, v51, v22, 0
  v_dot2_f32_bf16 v59, v51, v23, 0
  v_cvt_pk_bf16_f32 v60, v52, v53
  v_cvt_pk_bf16_f32 v61, v54, v55
  v_cvt_pk_bf16_f32 v62, v56, v57
  v_cvt_pk_bf16_f32 v63, v58, v59
  s_nop 1
  v_mfma_f32_16x16x32_bf16 v[68:71], v[60:63], v[4:7], 0
  s_waitcnt vmcnt(14)
  v_cvt_f32_i32 v176, v176
  v_cvt_f32_i32 v177, v177
  v_cvt_f32_i32 v178, v178
  v_cvt_f32_i32 v179, v179
  v_cvt_f32_i32 v180, v180
  v_cvt_f32_i32 v181, v181
  v_cvt_f32_i32 v182, v182
  v_cvt_f32_i32 v183, v183
  v_pk_add_f32 v[176:177], v[176:177], v[8:9] neg_lo:[0,1] neg_hi:[0,1]
  v_pk_add_f32 v[178:179], v[178:179], v[10:11] neg_lo:[0,1] neg_hi:[0,1]
  v_pk_add_f32 v[180:181], v[180:181], v[12:13] neg_lo:[0,1] neg_hi:[0,1]
  v_pk_add_f32 v[182:183], v[182:183], v[14:15] neg_lo:[0,1] neg_hi:[0,1]
  v_cvt_pk_bf16_f32 v48, v176, v177
  v_cvt_pk_bf16_f32 v49, v178, v179
  v_cvt_pk_bf16_f32 v50, v180, v181
  v_cvt_pk_bf16_f32 v51, v182, v183
  buffer_load_dwordx4 v[240:243], v1, s[36:39], s32 offen offset:3072 nt
  buffer_load_dwordx4 v[244:247], v1, s[36:39], s32 offen offset:3328 nt
  v_mov_b32_dpp v120, v68 quad_perm:[0,0,0,0] row_mask:0xf bank_mask:0xf
  v_mov_b32_dpp v121, v70 quad_perm:[2,2,2,2] row_mask:0xf bank_mask:0xf
  v_dot2_f32_bf16 v52, v48, v16, 0
  v_dot2_f32_bf16 v53, v48, v17, 0
  v_add_f32_dpp v120, v69, v120 quad_perm:[1,1,1,1] row_mask:0xf bank_mask:0xf
  v_add_f32_dpp v121, v71, v121 quad_perm:[3,3,3,3] row_mask:0xf bank_mask:0xf
  v_dot2_f32_bf16 v54, v49, v18, 0
  v_dot2_f32_bf16 v55, v49, v19, 0
  v_add_f32 v77, v120, v121
  v_dot2_f32_bf16 v56, v50, v20, 0
  v_dot2_f32_bf16 v57, v50, v21, 0
  v_dot2_f32_bf16 v58, v51, v22, 0
  v_dot2_f32_bf16 v59, v51, v23, 0
  v_cvt_pk_bf16_f32 v60, v52, v53
  v_cvt_pk_bf16_f32 v61, v54, v55
  v_cvt_pk_bf16_f32 v62, v56, v57
  v_cvt_pk_bf16_f32 v63, v58, v59
  s_nop 1
  v_mfma_f32_16x16x32_bf16 v[64:67], v[60:63], v[4:7], 0
  s_waitcnt vmcnt(14)
  v_cvt_f32_i32 v184, v184
  v_cvt_f32_i32 v185, v185
  v_cvt_f32_i32 v186, v186
  v_cvt_f32_i32 v187, v187
  v_cvt_f32_i32 v188, v188
  v_cvt_f32_i32 v189, v189
  v_cvt_f32_i32 v190, v190
  v_cvt_f32_i32 v191, v191
  v_pk_add_f32 v[184:185], v[184:185], v[8:9] neg_lo:[0,1] neg_hi:[0,1]
  v_pk_add_f32 v[186:187], v[186:187], v[10:11] neg_lo:[0,1] neg_hi:[0,1]
  v_pk_add_f32 v[188:189], v[188:189], v[12:13] neg_lo:[0,1] neg_hi:[0,1]
  v_pk_add_f32 v[190:191], v[190:191], v[14:15] neg_lo:[0,1] neg_hi:[0,1]
  v_cvt_pk_bf16_f32 v48, v184, v185
  v_cvt_pk_bf16_f32 v49, v186, v187
  v_cvt_pk_bf16_f32 v50, v188, v189
  v_cvt_pk_bf16_f32 v51, v190, v191
  buffer_load_dwordx4 v[248:251], v1, s[36:39], s32 offen offset:3584 nt
  buffer_load_dwordx4 v[252:255], v1, s[36:39], s32 offen offset:3840 nt
  v_mov_b32_dpp v120, v64 quad_perm:[0,0,0,0] row_mask:0xf bank_mask:0xf
  v_mov_b32_dpp v121, v66 quad_perm:[2,2,2,2] row_mask:0xf bank_mask:0xf
  v_dot2_f32_bf16 v52, v48, v16, 0
  v_dot2_f32_bf16 v53, v48, v17, 0
  v_add_f32_dpp v120, v65, v120 quad_perm:[1,1,1,1] row_mask:0xf bank_mask:0xf
  v_add_f32_dpp v121, v67, v121 quad_perm:[3,3,3,3] row_mask:0xf bank_mask:0xf
  v_dot2_f32_bf16 v54, v49, v18, 0
  v_dot2_f32_bf16 v55, v49, v19, 0
  v_add_f32 v78, v120, v121
  v_dot2_f32_bf16 v56, v50, v20, 0
  v_dot2_f32_bf16 v57, v50, v21, 0
  v_dot2_f32_bf16 v58, v51, v22, 0
  v_dot2_f32_bf16 v59, v51, v23, 0
  v_cvt_pk_bf16_f32 v60, v52, v53
  v_cvt_pk_bf16_f32 v61, v54, v55
  v_cvt_pk_bf16_f32 v62, v56, v57
  v_cvt_pk_bf16_f32 v63, v58, v59
  s_nop 1
  v_mfma_f32_16x16x32_bf16 v[68:71], v[60:63], v[4:7], 0
  v_bfe_u32 v118, v0, 2, 1
  v_cvt_pk_bf16_f32 v48, v72, v73
  v_cvt_pk_bf16_f32 v49, v74, v75
  v_cvt_pk_bf16_f32 v50, v76, v77
  v_lshl_add_u32 v118, v118, 6, v3
  v_lshlrev_b32 v72, 16, v48
  v_and_b32 v73, s68, v48
  v_lshlrev_b32 v74, 16, v49
  v_and_b32 v75, s68, v49
  v_lshlrev_b32 v76, 16, v50
  v_and_b32 v77, s68, v50
  v_mov_b32_dpp v120, v68 quad_perm:[0,0,0,0] row_mask:0xf bank_mask:0xf
  v_mov_b32_dpp v121, v70 quad_perm:[2,2,2,2] row_mask:0xf bank_mask:0xf
  v_mul_f32 v72, s67, v72
  v_mul_f32 v73, s67, v73
  v_add_f32_dpp v120, v69, v120 quad_perm:[1,1,1,1] row_mask:0xf bank_mask:0xf
  v_add_f32_dpp v121, v71, v121 quad_perm:[3,3,3,3] row_mask:0xf bank_mask:0xf
  v_mul_f32 v74, s67, v74
  v_mul_f32 v75, s67, v75
  v_mul_f32 v76, s67, v76
  v_mul_f32 v77, s67, v77
  v_add_f32 v79, v120, v121
  v_cvt_pk_bf16_f32 v51, v78, v79
  v_cvt_pk_bf16_f32 v48, v72, v73
  v_cvt_pk_bf16_f32 v49, v74, v75
  v_cvt_pk_bf16_f32 v50, v76, v77
  v_lshlrev_b32 v78, 16, v51
  v_and_b32 v79, s68, v51
  v_add_u32 v118, s48, v118
  v_mul_f32 v78, s67, v78
  v_mul_f32 v79, s67, v79
  s_add_u32 s48, s48, 128
  v_cvt_pk_bf16_f32 v51, v78, v79
  s_mov_b64 exec, s[50:51]
  ds_write_b128 v118, v[48:51]
  s_mov_b64 exec, -1
  v_max3_f32 v116, v72, v73, v116
  v_max3_f32 v116, v74, v75, v116
  v_max3_f32 v116, v76, v77, v116
  v_max3_f32 v116, v78, v79, v116
  s_cmp_lt_u32 s29, 5
  s_cbranch_scc0 L_Adyn
  s_add_u32 s28, s28, 8
  s_barrier
  s_cmp_eq_u32 s80, 0
  s_cbranch_scc1 L_Anext
  s_cmp_eq_u32 s29, 0
  s_cbranch_scc0 L_As2
  v_mov_b32 v118, -1
  v_mov_b32 v119, -1
  v_mov_b32 v120, -1
  v_mov_b32 v121, -1
  v_lshlrev_b32 v122, 4, v0
  v_lshrrev_b32 v123, 1, v0
  buffer_store_dwordx4 v[118:121], v122, s[60:63], s83 offen sc1
  s_mov_b64 exec, 0x10001
  buffer_store_dwordx2 v[118:119], v123, s[60:63], s83 offen offset:1024 sc1
  s_mov_b64 exec, -1
  s_cmp_eq_u32 s81, 0
  s_cbranch_scc1 L_Anext
  v_mov_b32 v126, 1
  s_mov_b64 exec, 1
  buffer_store_byte v126, off, s[76:79], s7 sc1
  s_mov_b64 exec, -1
  s_branch L_Anext
L_As2:
  s_cmp_eq_u32 s29, 1
  s_cbranch_scc0 L_As2b
  s_lshl_b32 s71, s26, 2
  s_add_u32 s71, s71, 128
  v_mov_b32 v127, 1
  s_mov_b64 exec, 1
  buffer_atomic_add v127, off, s[76:79], s71 sc0 sc1
  s_mov_b64 exec, -1
L_As2b:
  s_cmp_eq_u32 s29, 3
  s_cbranch_scc0 L_As3
  s_mov_b64 exec, 1
  buffer_load_ubyte v126, off, s[76:79], s7 sc1
  s_mov_b64 exec, -1
  s_branch L_Anext
L_As3:
  s_cmp_eq_u32 s29, 4
  s_cbranch_scc0 L_Anext
  v_readfirstlane_b32 s70, v126
  s_or_b32 s74, s74, s70
  s_branch L_Aclaim
L_Adyn:
  s_lshl_b32 s71, s29, 2
  v_mov_b32 v119, s71
  s_cmp_eq_u32 s80, 0
  s_cbranch_scc1 L_Async
  v_readfirstlane_b32 s70, v126
  s_add_u32 s70, s70, 48
  s_min_u32 s70, s70, 56
  s_cmp_eq_u32 s74, 0
  s_cselect_b32 s70, 56, s70
  v_mov_b32 v118, s70
  ds_write_b32 v119, v118 offset:28676
  s_waitcnt lgkmcnt(0)
L_Async:
  s_barrier
  ds_read_b32 v119, v119 offset:28676
  s_waitcnt lgkmcnt(0)
  v_readfirstlane_b32 s28, v119
  s_cmp_lt_u32 s28, 56
  s_cbranch_scc0 L_Alast
  s_cmp_eq_u32 s80, 0
  s_cbranch_scc1 L_Anext
L_Aclaim:
  s_cmp_eq_u32 s74, 0
  s_cbranch_scc1 L_Anext
  v_mov_b32 v126, 1
  s_mov_b64 exec, 1
  buffer_atomic_add v126, off, s[60:63], s6 sc0 sc1
  s_mov_b64 exec, -1
L_Anext:
  s_lshr_b32 s70, s28, 3
  s_lshl_b32 s70, s70, 1
  s_add_u32 s70, s70, s26
  s_and_b32 s70, s70, 15
  s_lshl_b32 s70, s70, 3
  s_and_b32 s71, s28, 7
  s_lshl_b32 s71, s71, 7
  s_add_u32 s70, s70, s71
  s_add_u32 s70, s70, s27
  s_lshl_b32 s70, s70, 14
  s_waitcnt vmcnt(14)
  v_cvt_f32_i32 v192, v192
  v_cvt_f32_i32 v193, v193
  v_cvt_f32_i32 v194, v194
  v_cvt_f32_i32 v195, v195
  v_cvt_f32_i32 v196, v196
  v_cvt_f32_i32 v197, v197
  v_cvt_f32_i32 v198, v198
  v_cvt_f32_i32 v199, v199
  v_pk_add_f32 v[192:193], v[192:193], v[8:9] neg_lo:[0,1] neg_hi:[0,1]
  v_pk_add_f32 v[194:195], v[194:195], v[10:11] neg_lo:[0,1] neg_hi:[0,1]
  v_pk_add_f32 v[196:197], v[196:197], v[12:13] neg_lo:[0,1] neg_hi:[0,1]
  v_pk_add_f32 v[198:199], v[198:199], v[14:15] neg_lo:[0,1] neg_hi:[0,1]
  v_cvt_pk_bf16_f32 v48, v192, v193
  v_cvt_pk_bf16_f32 v49, v194, v195
  v_cvt_pk_bf16_f32 v50, v196, v197
  v_cvt_pk_bf16_f32 v51, v198, v199
  buffer_load_dwordx4 v[128:131], v1, s[36:39], s70 offen offset:0 nt
  buffer_load_dwordx4 v[132:135], v1, s[36:39], s70 offen offset:256 nt
  v_dot2_f32_bf16 v52, v48, v16, 0
  v_dot2_f32_bf16 v53, v48, v17, 0
  v_dot2_f32_bf16 v54, v49, v18, 0
  v_dot2_f32_bf16 v55, v49, v19, 0
  v_dot2_f32_bf16 v56, v50, v20, 0
  v_dot2_f32_bf16 v57, v50, v21, 0
  v_dot2_f32_bf16 v58, v51, v22, 0
  v_dot2_f32_bf16 v59, v51, v23, 0
  v_cvt_pk_bf16_f32 v60, v52, v53
  v_cvt_pk_bf16_f32 v61, v54, v55
  v_cvt_pk_bf16_f32 v62, v56, v57
  v_cvt_pk_bf16_f32 v63, v58, v59
  s_nop 1
  v_mfma_f32_16x16x32_bf16 v[64:67], v[60:63], v[4:7], 0
  s_waitcnt vmcnt(14)
  v_cvt_f32_i32 v200, v200
  v_cvt_f32_i32 v201, v201
  v_cvt_f32_i32 v202, v202
  v_cvt_f32_i32 v203, v203
  v_cvt_f32_i32 v204, v204
  v_cvt_f32_i32 v205, v205
  v_cvt_f32_i32 v206, v206
  v_cvt_f32_i32 v207, v207
  v_pk_add_f32 v[200:201], v[200:201], v[8:9] neg_lo:[0,1] neg_hi:[0,1]
  v_pk_add_f32 v[202:203], v[202:203], v[10:11] neg_lo:[0,1] neg_hi:[0,1]
  v_pk_add_f32 v[204:205], v[204:205], v[12:13] neg_lo:[0,1] neg_hi:[0,1]
  v_pk_add_f32 v[206:207], v[206:207], v[14:15] neg_lo:[0,1] neg_hi:[0,1]
  v_cvt_pk_bf16_f32 v48, v200, v201
  v_cvt_pk_bf16_f32 v49, v202, v203
  v_cvt_pk_bf16_f32 v50, v204, v205
  v_cvt_pk_bf16_f32 v51, v206, v207
  buffer_load_dwordx4 v[136:139], v1, s[36:39], s70 offen offset:512 nt
  buffer_load_dwordx4 v[140:143], v1, s[36:39], s70 offen offset:768 nt
  v_mov_b32_dpp v120, v64 quad_perm:[0,0,0,0] row_mask:0xf bank_mask:0xf
  v_mov_b32_dpp v121, v66 quad_perm:[2,2,2,2] row_mask:0xf bank_mask:0xf
  v_dot2_f32_bf16 v52, v48, v16, 0
  v_dot2_f32_bf16 v53, v48, v17, 0
  v_add_f32_dpp v120, v65, v120 quad_perm:[1,1,1,1] row_mask:0xf bank_mask:0xf
  v_add_f32_dpp v121, v67, v121 quad_perm:[3,3,3,3] row_mask:0xf bank_mask:0xf
  v_dot2_f32_bf16 v54, v49, v18, 0
  v_dot2_f32_bf16 v55, v49, v19, 0
  v_add_f32 v72, v120, v121
  v_dot2_f32_bf16 v56, v50, v20, 0
  v_dot2_f32_bf16 v57, v50, v21, 0
  v_dot2_f32_bf16 v58, v51, v22, 0
  v_dot2_f32_bf16 v59, v51, v23, 0
  v_cvt_pk_bf16_f32 v60, v52, v53
  v_cvt_pk_bf16_f32 v61, v54, v55
  v_cvt_pk_bf16_f32 v62, v56, v57
  v_cvt_pk_bf16_f32 v63, v58, v59
  s_nop 1
  v_mfma_f32_16x16x32_bf16 v[68:71], v[60:63], v[4:7], 0
  s_waitcnt vmcnt(14)
  v_cvt_f32_i32 v208, v208
  v_cvt_f32_i32 v209, v209
  v_cvt_f32_i32 v210, v210
  v_cvt_f32_i32 v211, v211
  v_cvt_f32_i32 v212, v212
  v_cvt_f32_i32 v213, v213
  v_cvt_f32_i32 v214, v214
  v_cvt_f32_i32 v215, v215
  v_pk_add_f32 v[208:209], v[208:209], v[8:9] neg_lo:[0,1] neg_hi:[0,1]
  v_pk_add_f32 v[210:211], v[210:211], v[10:11] neg_lo:[0,1] neg_hi:[0,1]
  v_pk_add_f32 v[212:213], v[212:213], v[12:13] neg_lo:[0,1] neg_hi:[0,1]
  v_pk_add_f32 v[214:215], v[214:215], v[14:15] neg_lo:[0,1] neg_hi:[0,1]
  v_cvt_pk_bf16_f32 v48, v208, v209
  v_cvt_pk_bf16_f32 v49, v210, v211
  v_cvt_pk_bf16_f32 v50, v212, v213
  v_cvt_pk_bf16_f32 v51, v214, v215
  buffer_load_dwordx4 v[144:147], v1, s[36:39], s70 offen offset:1024 nt
  buffer_load_dwordx4 v[148:151], v1, s[36:39], s70 offen offset:1280 nt
  v_mov_b32_dpp v120, v68 quad_perm:[0,0,0,0] row_mask:0xf bank_mask:0xf
  v_mov_b32_dpp v121, v70 quad_perm:[2,2,2,2] row_mask:0xf bank_mask:0xf
  v_dot2_f32_bf16 v52, v48, v16, 0
  v_dot2_f32_bf16 v53, v48, v17, 0
  v_add_f32_dpp v120, v69, v120 quad_perm:[1,1,1,1] row_mask:0xf bank_mask:0xf
  v_add_f32_dpp v121, v71, v121 quad_perm:[3,3,3,3] row_mask:0xf bank_mask:0xf
  v_dot2_f32_bf16 v54, v49, v18, 0
  v_dot2_f32_bf16 v55, v49, v19, 0
  v_add_f32 v73, v120, v121
  v_dot2_f32_bf16 v56, v50, v20, 0
  v_dot2_f32_bf16 v57, v50, v21, 0
  v_dot2_f32_bf16 v58, v51, v22, 0
  v_dot2_f32_bf16 v59, v51, v23, 0
  v_cvt_pk_bf16_f32 v60, v52, v53
  v_cvt_pk_bf16_f32 v61, v54, v55
  v_cvt_pk_bf16_f32 v62, v56, v57
  v_cvt_pk_bf16_f32 v63, v58, v59
  s_nop 1
  v_mfma_f32_16x16x32_bf16 v[64:67], v[60:63], v[4:7], 0
  s_waitcnt vmcnt(14)
  v_cvt_f32_i32 v216, v216
  v_cvt_f32_i32 v217, v217
  v_cvt_f32_i32 v218, v218
  v_cvt_f32_i32 v219, v219
  v_cvt_f32_i32 v220, v220
  v_cvt_f32_i32 v221, v221
  v_cvt_f32_i32 v222, v222
  v_cvt_f32_i32 v223, v223
  v_pk_add_f32 v[216:217], v[216:217], v[8:9] neg_lo:[0,1] neg_hi:[0,1]
  v_pk_add_f32 v[218:219], v[218:219], v[10:11] neg_lo:[0,1] neg_hi:[0,1]
  v_pk_add_f32 v[220:221], v[220:221], v[12:13] neg_lo:[0,1] neg_hi:[0,1]
  v_pk_add_f32 v[222:223], v[222:223], v[14:15] neg_lo:[0,1] neg_hi:[0,1]
  v_cvt_pk_bf16_f32 v48, v216, v217
  v_cvt_pk_bf16_f32 v49, v218, v219
  v_cvt_pk_bf16_f32 v50, v220, v221
  v_cvt_pk_bf16_f32 v51, v222, v223
  buffer_load_dwordx4 v[152:155], v1, s[36:39], s70 offen offset:1536 nt
  buffer_load_dwordx4 v[156:159], v1, s[36:39], s70 offen offset:1792 nt
  v_mov_b32_dpp v120, v64 quad_perm:[0,0,0,0] row_mask:0xf bank_mask:0xf
  v_mov_b32_dpp v121, v66 quad_perm:[2,2,2,2] row_mask:0xf bank_mask:0xf
  v_dot2_f32_bf16 v52, v48, v16, 0
  v_dot2_f32_bf16 v53, v48, v17, 0
  v_add_f32_dpp v120, v65, v120 quad_perm:[1,1,1,1] row_mask:0xf bank_mask:0xf
  v_add_f32_dpp v121, v67, v121 quad_perm:[3,3,3,3] row_mask:0xf bank_mask:0xf
  v_dot2_f32_bf16 v54, v49, v18, 0
  v_dot2_f32_bf16 v55, v49, v19, 0
  v_add_f32 v74, v120, v121
  v_dot2_f32_bf16 v56, v50, v20, 0
  v_dot2_f32_bf16 v57, v50, v21, 0
  v_dot2_f32_bf16 v58, v51, v22, 0
  v_dot2_f32_bf16 v59, v51, v23, 0
  v_cvt_pk_bf16_f32 v60, v52, v53
  v_cvt_pk_bf16_f32 v61, v54, v55
  v_cvt_pk_bf16_f32 v62, v56, v57
  v_cvt_pk_bf16_f32 v63, v58, v59
  s_nop 1
  v_mfma_f32_16x16x32_bf16 v[68:71], v[60:63], v[4:7], 0
  s_waitcnt vmcnt(14)
  v_cvt_f32_i32 v224, v224
  v_cvt_f32_i32 v225, v225
  v_cvt_f32_i32 v226, v226
  v_cvt_f32_i32 v227, v227
  v_cvt_f32_i32 v228, v228
  v_cvt_f32_i32 v229, v229
  v_cvt_f32_i32 v230, v230
  v_cvt_f32_i32 v231, v231
  v_pk_add_f32 v[224:225], v[224:225], v[8:9] neg_lo:[0,1] neg_hi:[0,1]
  v_pk_add_f32 v[226:227], v[226:227], v[10:11] neg_lo:[0,1] neg_hi:[0,1]
  v_pk_add_f32 v[228:229], v[228:229], v[12:13] neg_lo:[0,1] neg_hi:[0,1]
  v_pk_add_f32 v[230:231], v[230:231], v[14:15] neg_lo:[0,1] neg_hi:[0,1]
  v_cvt_pk_bf16_f32 v48, v224, v225
  v_cvt_pk_bf16_f32 v49, v226, v227
  v_cvt_pk_bf16_f32 v50, v228, v229
  v_cvt_pk_bf16_f32 v51, v230, v231
  buffer_load_dwordx4 v[160:163], v1, s[36:39], s70 offen offset:2048 nt
  buffer_load_dwordx4 v[164:167], v1, s[36:39], s70 offen offset:2304 nt
  v_mov_b32_dpp v120, v68 quad_perm:[0,0,0,0] row_mask:0xf bank_mask:0xf
  v_mov_b32_dpp v121, v70 quad_perm:[2,2,2,2] row_mask:0xf bank_mask:0xf
  v_dot2_f32_bf16 v52, v48, v16, 0
  v_dot2_f32_bf16 v53, v48, v17, 0
  v_add_f32_dpp v120, v69, v120 quad_perm:[1,1,1,1] row_mask:0xf bank_mask:0xf
  v_add_f32_dpp v121, v71, v121 quad_perm:[3,3,3,3] row_mask:0xf bank_mask:0xf
  v_dot2_f32_bf16 v54, v49, v18, 0
  v_dot2_f32_bf16 v55, v49, v19, 0
  v_add_f32 v75, v120, v121
  v_dot2_f32_bf16 v56, v50, v20, 0
  v_dot2_f32_bf16 v57, v50, v21, 0
  v_dot2_f32_bf16 v58, v51, v22, 0
  v_dot2_f32_bf16 v59, v51, v23, 0
  v_cvt_pk_bf16_f32 v60, v52, v53
  v_cvt_pk_bf16_f32 v61, v54, v55
  v_cvt_pk_bf16_f32 v62, v56, v57
  v_cvt_pk_bf16_f32 v63, v58, v59
  s_nop 1
  v_mfma_f32_16x16x32_bf16 v[64:67], v[60:63], v[4:7], 0
  s_waitcnt vmcnt(14)
  v_cvt_f32_i32 v232, v232
  v_cvt_f32_i32 v233, v233
  v_cvt_f32_i32 v234, v234
  v_cvt_f32_i32 v235, v235
  v_cvt_f32_i32 v236, v236
  v_cvt_f32_i32 v237, v237
  v_cvt_f32_i32 v238, v238
  v_cvt_f32_i32 v239, v239
  v_pk_add_f32 v[232:233], v[232:233], v[8:9] neg_lo:[0,1] neg_hi:[0,1]
  v_pk_add_f32 v[234:235], v[234:235], v[10:11] neg_lo:[0,1] neg_hi:[0,1]
  v_pk_add_f32 v[236:237], v[236:237], v[12:13] neg_lo:[0,1] neg_hi:[0,1]
  v_pk_add_f32 v[238:239], v[238:239], v[14:15] neg_lo:[0,1] neg_hi:[0,1]
  v_cvt_pk_bf16_f32 v48, v232, v233
  v_cvt_pk_bf16_f32 v49, v234, v235
  v_cvt_pk_bf16_f32 v50, v236, v237
  v_cvt_pk_bf16_f32 v51, v238, v239
  buffer_load_dwordx4 v[168:171], v1, s[36:39], s70 offen offset:2560 nt
  buffer_load_dwordx4 v[172:175], v1, s[36:39], s70 offen offset:2816 nt
  v_mov_b32_dpp v120, v64 quad_perm:[0,0,0,0] row_mask:0xf bank_mask:0xf
  v_mov_b32_dpp v121, v66 quad_perm:[2,2,2,2] row_mask:0xf bank_mask:0xf
  v_dot2_f32_bf16 v52, v48, v16, 0
  v_dot2_f32_bf16 v53, v48, v17, 0
  v_add_f32_dpp v120, v65, v120 quad_perm:[1,1,1,1] row_mask:0xf bank_mask:0xf
  v_add_f32_dpp v121, v67, v121 quad_perm:[3,3,3,3] row_mask:0xf bank_mask:0xf
  v_dot2_f32_bf16 v54, v49, v18, 0
  v_dot2_f32_bf16 v55, v49, v19, 0
  v_add_f32 v76, v120, v121
  v_dot2_f32_bf16 v56, v50, v20, 0
  v_dot2_f32_bf16 v57, v50, v21, 0
  v_dot2_f32_bf16 v58, v51, v22, 0
  v_dot2_f32_bf16 v59, v51, v23, 0
  v_cvt_pk_bf16_f32 v60, v52, v53
  v_cvt_pk_bf16_f32 v61, v54, v55
  v_cvt_pk_bf16_f32 v62, v56, v57
  v_cvt_pk_bf16_f32 v63, v58, v59
  s_nop 1
  v_mfma_f32_16x16x32_bf16 v[68:71], v[60:63], v[4:7], 0
  s_waitcnt vmcnt(14)
  v_cvt_f32_i32 v240, v240
  v_cvt_f32_i32 v241, v241
  v_cvt_f32_i32 v242, v242
  v_cvt_f32_i32 v243, v243
  v_cvt_f32_i32 v244, v244
  v_cvt_f32_i32 v245, v245
  v_cvt_f32_i32 v246, v246
  v_cvt_f32_i32 v247, v247
  v_pk_add_f32 v[240:241], v[240:241], v[8:9] neg_lo:[0,1] neg_hi:[0,1]
  v_pk_add_f32 v[242:243], v[242:243], v[10:11] neg_lo:[0,1] neg_hi:[0,1]
  v_pk_add_f32 v[244:245], v[244:245], v[12:13] neg_lo:[0,1] neg_hi:[0,1]
  v_pk_add_f32 v[246:247], v[246:247], v[14:15] neg_lo:[0,1] neg_hi:[0,1]
  v_cvt_pk_bf16_f32 v48, v240, v241
  v_cvt_pk_bf16_f32 v49, v242, v243
  v_cvt_pk_bf16_f32 v50, v244, v245
  v_cvt_pk_bf16_f32 v51, v246, v247
  buffer_load_dwordx4 v[176:179], v1, s[36:39], s70 offen offset:3072 nt
  buffer_load_dwordx4 v[180:183], v1, s[36:39], s70 offen offset:3328 nt
  v_mov_b32_dpp v120, v68 quad_perm:[0,0,0,0] row_mask:0xf bank_mask:0xf
  v_mov_b32_dpp v121, v70 quad_perm:[2,2,2,2] row_mask:0xf bank_mask:0xf
  v_dot2_f32_bf16 v52, v48, v16, 0
  v_dot2_f32_bf16 v53, v48, v17, 0
  v_add_f32_dpp v120, v69, v120 quad_perm:[1,1,1,1] row_mask:0xf bank_mask:0xf
  v_add_f32_dpp v121, v71, v121 quad_perm:[3,3,3,3] row_mask:0xf bank_mask:0xf
  v_dot2_f32_bf16 v54, v49, v18, 0
  v_dot2_f32_bf16 v55, v49, v19, 0
  v_add_f32 v77, v120, v121
  v_dot2_f32_bf16 v56, v50, v20, 0
  v_dot2_f32_bf16 v57, v50, v21, 0
  v_dot2_f32_bf16 v58, v51, v22, 0
  v_dot2_f32_bf16 v59, v51, v23, 0
  v_cvt_pk_bf16_f32 v60, v52, v53
  v_cvt_pk_bf16_f32 v61, v54, v55
  v_cvt_pk_bf16_f32 v62, v56, v57
  v_cvt_pk_bf16_f32 v63, v58, v59
  s_nop 1
  v_mfma_f32_16x16x32_bf16 v[64:67], v[60:63], v[4:7], 0
  s_waitcnt vmcnt(14)
  v_cvt_f32_i32 v248, v248
  v_cvt_f32_i32 v249, v249
  v_cvt_f32_i32 v250, v250
  v_cvt_f32_i32 v251, v251
  v_cvt_f32_i32 v252, v252
  v_cvt_f32_i32 v253, v253
  v_cvt_f32_i32 v254, v254
  v_cvt_f32_i32 v255, v255
  v_pk_add_f32 v[248:249], v[248:249], v[8:9] neg_lo:[0,1] neg_hi:[0,1]
  v_pk_add_f32 v[250:251], v[250:251], v[10:11] neg_lo:[0,1] neg_hi:[0,1]
  v_pk_add_f32 v[252:253], v[252:253], v[12:13] neg_lo:[0,1] neg_hi:[0,1]
  v_pk_add_f32 v[254:255], v[254:255], v[14:15] neg_lo:[0,1] neg_hi:[0,1]
  v_cvt_pk_bf16_f32 v48, v248, v249
  v_cvt_pk_bf16_f32 v49, v250, v251
  v_cvt_pk_bf16_f32 v50, v252, v253
  v_cvt_pk_bf16_f32 v51, v254, v255
  buffer_load_dwordx4 v[184:187], v1, s[36:39], s70 offen offset:3584 nt
  buffer_load_dwordx4 v[188:191], v1, s[36:39], s70 offen offset:3840 nt
  v_mov_b32_dpp v120, v64 quad_perm:[0,0,0,0] row_mask:0xf bank_mask:0xf
  v_mov_b32_dpp v121, v66 quad_perm:[2,2,2,2] row_mask:0xf bank_mask:0xf
  v_dot2_f32_bf16 v52, v48, v16, 0
  v_dot2_f32_bf16 v53, v48, v17, 0
  v_add_f32_dpp v120, v65, v120 quad_perm:[1,1,1,1] row_mask:0xf bank_mask:0xf
  v_add_f32_dpp v121, v67, v121 quad_perm:[3,3,3,3] row_mask:0xf bank_mask:0xf
  v_dot2_f32_bf16 v54, v49, v18, 0
  v_dot2_f32_bf16 v55, v49, v19, 0
  v_add_f32 v78, v120, v121
  v_dot2_f32_bf16 v56, v50, v20, 0
  v_dot2_f32_bf16 v57, v50, v21, 0
  v_dot2_f32_bf16 v58, v51, v22, 0
  v_dot2_f32_bf16 v59, v51, v23, 0
  v_cvt_pk_bf16_f32 v60, v52, v53
  v_cvt_pk_bf16_f32 v61, v54, v55
  v_cvt_pk_bf16_f32 v62, v56, v57
  v_cvt_pk_bf16_f32 v63, v58, v59
  s_nop 1
  v_mfma_f32_16x16x32_bf16 v[68:71], v[60:63], v[4:7], 0
  v_bfe_u32 v118, v0, 2, 1
  v_cvt_pk_bf16_f32 v48, v72, v73
  v_cvt_pk_bf16_f32 v49, v74, v75
  v_cvt_pk_bf16_f32 v50, v76, v77
  v_lshl_add_u32 v118, v118, 6, v3
  v_lshlrev_b32 v72, 16, v48
  v_and_b32 v73, s68, v48
  v_lshlrev_b32 v74, 16, v49
  v_and_b32 v75, s68, v49
  v_lshlrev_b32 v76, 16, v50
  v_and_b32 v77, s68, v50
  v_mov_b32_dpp v120, v68 quad_perm:[0,0,0,0] row_mask:0xf bank_mask:0xf
  v_mov_b32_dpp v121, v70 quad_perm:[2,2,2,2] row_mask:0xf bank_mask:0xf
  v_mul_f32 v72, s67, v72
  v_mul_f32 v73, s67, v73
  v_add_f32_dpp v120, v69, v120 quad_perm:[1,1,1,1] row_mask:0xf bank_mask:0xf
  v_add_f32_dpp v121, v71, v121 quad_perm:[3,3,3,3] row_mask:0xf bank_mask:0xf
  v_mul_f32 v74, s67, v74
  v_mul_f32 v75, s67, v75
  v_mul_f32 v76, s67, v76
  v_mul_f32 v77, s67, v77
  v_add_f32 v79, v120, v121
  v_cvt_pk_bf16_f32 v51, v78, v79
  v_cvt_pk_bf16_f32 v48, v72, v73
  v_cvt_pk_bf16_f32 v49, v74, v75
  v_cvt_pk_bf16_f32 v50, v76, v77
  v_lshlrev_b32 v78, 16, v51
  v_and_b32 v79, s68, v51
  v_add_u32 v118, s48, v118
  v_mul_f32 v78, s67, v78
  v_mul_f32 v79, s67, v79
  s_add_u32 s48, s48, 128
  v_cvt_pk_bf16_f32 v51, v78, v79
  s_mov_b64 exec, s[50:51]
  ds_write_b128 v118, v[48:51]
  s_mov_b64 exec, -1
  v_max3_f32 v116, v72, v73, v116
  v_max3_f32 v116, v74, v75, v116
  v_max3_f32 v116, v76, v77, v116
  v_max3_f32 v116, v78, v79, v116
  s_mov_b32 s72, s70
  s_add_u32 s32, s72, 0x20000
  s_and_b32 s32, s32, 0x1e0000
  s_andn2_b32 s73, s72, 0x1e0000
  s_or_b32 s32, s32, s73
  s_add_u32 s29, s29, 1
  s_branch L_A
L_Alast:
  s_lshr_b32 s70, s25, 3
  s_lshl_b32 s70, s70, 1
  s_add_u32 s70, s70, s26
  s_and_b32 s70, s70, 15
  s_lshl_b32 s70, s70, 3
  s_and_b32 s71, s25, 7
  s_lshl_b32 s71, s71, 7
  s_add_u32 s70, s70, s71
  s_add_u32 s70, s70, s27
  s_lshl_b32 s70, s70, 14
  v_bfe_u32 v118, v0, 2, 1
  s_lshr_b32 s4, s70, 8
  v_lshl_add_u32 v118, v118, 6, v3
  buffer_load_dwordx4 v[24:27], v3, s[52:55], s4 offen nt
  v_add_u32 v118, s49, v118
  buffer_load_dwordx4 v[28:31], v3, s[56:59], s4 offen nt
  ds_read_b128 v[122:125], v118
  s_add_u32 s49, s49, 128
  s_waitcnt vmcnt(16)
  v_cvt_f32_i32 v192, v192
  v_cvt_f32_i32 v193, v193
  v_cvt_f32_i32 v194, v194
  v_cvt_f32_i32 v195, v195
  v_cvt_f32_i32 v196, v196
  v_cvt_f32_i32 v197, v197
  v_cvt_f32_i32 v198, v198
  v_cvt_f32_i32 v199, v199
  v_pk_add_f32 v[192:193], v[192:193], v[8:9] neg_lo:[0,1] neg_hi:[0,1]
  v_pk_add_f32 v[194:195], v[194:195], v[10:11] neg_lo:[0,1] neg_hi:[0,1]
  v_pk_add_f32 v[196:197], v[196:197], v[12:13] neg_lo:[0,1] neg_hi:[0,1]
  v_pk_add_f32 v[198:199], v[198:199], v[14:15] neg_lo:[0,1] neg_hi:[0,1]
  v_cvt_pk_bf16_f32 v48, v192, v193
  v_cvt_pk_bf16_f32 v49, v194, v195
  v_cvt_pk_bf16_f32 v50, v196, v197
  v_cvt_pk_bf16_f32 v51, v198, v199
  buffer_load_dwordx4 v[128:131], v2, s[40:43], s70 offen offset:0 nt
  buffer_load_dwordx4 v[132:135], v2, s[40:43], s70 offen offset:512 nt
  v_dot2_f32_bf16 v52, v48, v16, 0
  v_dot2_f32_bf16 v53, v48, v17, 0
  v_dot2_f32_bf16 v54, v49, v18, 0
  v_dot2_f32_bf16 v55, v49, v19, 0
  v_dot2_f32_bf16 v56, v50, v20, 0
  v_dot2_f32_bf16 v57, v50, v21, 0
  v_dot2_f32_bf16 v58, v51, v22, 0
  v_dot2_f32_bf16 v59, v51, v23, 0
  v_cvt_pk_bf16_f32 v60, v52, v53
  v_cvt_pk_bf16_f32 v61, v54, v55
  v_cvt_pk_bf16_f32 v62, v56, v57
  v_cvt_pk_bf16_f32 v63, v58, v59
  s_nop 1
  v_mfma_f32_16x16x32_bf16 v[64:67], v[60:63], v[4:7], 0
  s_waitcnt vmcnt(16)
  v_cvt_f32_i32 v200, v200
  v_cvt_f32_i32 v201, v201
  v_cvt_f32_i32 v202, v202
  v_cvt_f32_i32 v203, v203
  v_cvt_f32_i32 v204, v204
  v_cvt_f32_i32 v205, v205
  v_cvt_f32_i32 v206, v206
  v_cvt_f32_i32 v207, v207
  v_pk_add_f32 v[200:201], v[200:201], v[8:9] neg_lo:[0,1] neg_hi:[0,1]
  v_pk_add_f32 v[202:203], v[202:203], v[10:11] neg_lo:[0,1] neg_hi:[0,1]
  v_pk_add_f32 v[204:205], v[204:205], v[12:13] neg_lo:[0,1] neg_hi:[0,1]
  v_pk_add_f32 v[206:207], v[206:207], v[14:15] neg_lo:[0,1] neg_hi:[0,1]
  v_cvt_pk_bf16_f32 v48, v200, v201
  v_cvt_pk_bf16_f32 v49, v202, v203
  v_cvt_pk_bf16_f32 v50, v204, v205
  v_cvt_pk_bf16_f32 v51, v206, v207
  buffer_load_dwordx4 v[136:139], v2, s[40:43], s70 offen offset:256 nt
  buffer_load_dwordx4 v[140:143], v2, s[40:43], s70 offen offset:768 nt
  v_mov_b32_dpp v120, v64 quad_perm:[0,0,0,0] row_mask:0xf bank_mask:0xf
  v_mov_b32_dpp v121, v66 quad_perm:[2,2,2,2] row_mask:0xf bank_mask:0xf
  v_dot2_f32_bf16 v52, v48, v16, 0
  v_dot2_f32_bf16 v53, v48, v17, 0
  v_add_f32_dpp v120, v65, v120 quad_perm:[1,1,1,1] row_mask:0xf bank_mask:0xf
  v_add_f32_dpp v121, v67, v121 quad_perm:[3,3,3,3] row_mask:0xf bank_mask:0xf
  v_dot2_f32_bf16 v54, v49, v18, 0
  v_dot2_f32_bf16 v55, v49, v19, 0
  v_add_f32 v72, v120, v121
  v_dot2_f32_bf16 v56, v50, v20, 0
  v_dot2_f32_bf16 v57, v50, v21, 0
  v_dot2_f32_bf16 v58, v51, v22, 0
  v_dot2_f32_bf16 v59, v51, v23, 0
  v_cvt_pk_bf16_f32 v60, v52, v53
  v_cvt_pk_bf16_f32 v61, v54, v55
  v_cvt_pk_bf16_f32 v62, v56, v57
  v_cvt_pk_bf16_f32 v63, v58, v59
  s_nop 1
  v_mfma_f32_16x16x32_bf16 v[68:71], v[60:63], v[4:7], 0
  s_waitcnt vmcnt(16)
  v_cvt_f32_i32 v208, v208
  v_cvt_f32_i32 v209, v209
  v_cvt_f32_i32 v210, v210
  v_cvt_f32_i32 v211, v211
  v_cvt_f32_i32 v212, v212
  v_cvt_f32_i32 v213, v213
  v_cvt_f32_i32 v214, v214
  v_cvt_f32_i32 v215, v215
  v_pk_add_f32 v[208:209], v[208:209], v[8:9] neg_lo:[0,1] neg_hi:[0,1]
  v_pk_add_f32 v[210:211], v[210:211], v[10:11] neg_lo:[0,1] neg_hi:[0,1]
  v_pk_add_f32 v[212:213], v[212:213], v[12:13] neg_lo:[0,1] neg_hi:[0,1]
  v_pk_add_f32 v[214:215], v[214:215], v[14:15] neg_lo:[0,1] neg_hi:[0,1]
  v_cvt_pk_bf16_f32 v48, v208, v209
  v_cvt_pk_bf16_f32 v49, v210, v211
  v_cvt_pk_bf16_f32 v50, v212, v213
  v_cvt_pk_bf16_f32 v51, v214, v215
  buffer_load_dwordx4 v[144:147], v2, s[40:43], s70 offen offset:1024 nt
  buffer_load_dwordx4 v[148:151], v2, s[40:43], s70 offen offset:1536 nt
  v_mov_b32_dpp v120, v68 quad_perm:[0,0,0,0] row_mask:0xf bank_mask:0xf
  v_mov_b32_dpp v121, v70 quad_perm:[2,2,2,2] row_mask:0xf bank_mask:0xf
  v_dot2_f32_bf16 v52, v48, v16, 0
  v_dot2_f32_bf16 v53, v48, v17, 0
  v_add_f32_dpp v120, v69, v120 quad_perm:[1,1,1,1] row_mask:0xf bank_mask:0xf
  v_add_f32_dpp v121, v71, v121 quad_perm:[3,3,3,3] row_mask:0xf bank_mask:0xf
  v_dot2_f32_bf16 v54, v49, v18, 0
  v_dot2_f32_bf16 v55, v49, v19, 0
  v_add_f32 v73, v120, v121
  v_dot2_f32_bf16 v56, v50, v20, 0
  v_dot2_f32_bf16 v57, v50, v21, 0
  v_dot2_f32_bf16 v58, v51, v22, 0
  v_dot2_f32_bf16 v59, v51, v23, 0
  v_cvt_pk_bf16_f32 v60, v52, v53
  v_cvt_pk_bf16_f32 v61, v54, v55
  v_cvt_pk_bf16_f32 v62, v56, v57
  v_cvt_pk_bf16_f32 v63, v58, v59
  s_nop 1
  v_mfma_f32_16x16x32_bf16 v[64:67], v[60:63], v[4:7], 0
  s_waitcnt vmcnt(16)
  v_cvt_f32_i32 v216, v216
  v_cvt_f32_i32 v217, v217
  v_cvt_f32_i32 v218, v218
  v_cvt_f32_i32 v219, v219
  v_cvt_f32_i32 v220, v220
  v_cvt_f32_i32 v221, v221
  v_cvt_f32_i32 v222, v222
  v_cvt_f32_i32 v223, v223
  v_pk_add_f32 v[216:217], v[216:217], v[8:9] neg_lo:[0,1] neg_hi:[0,1]
  v_pk_add_f32 v[218:219], v[218:219], v[10:11] neg_lo:[0,1] neg_hi:[0,1]
  v_pk_add_f32 v[220:221], v[220:221], v[12:13] neg_lo:[0,1] neg_hi:[0,1]
  v_pk_add_f32 v[222:223], v[222:223], v[14:15] neg_lo:[0,1] neg_hi:[0,1]
  v_cvt_pk_bf16_f32 v48, v216, v217
  v_cvt_pk_bf16_f32 v49, v218, v219
  v_cvt_pk_bf16_f32 v50, v220, v221
  v_cvt_pk_bf16_f32 v51, v222, v223
  buffer_load_dwordx4 v[152:155], v2, s[40:43], s70 offen offset:1280 nt
  buffer_load_dwordx4 v[156:159], v2, s[40:43], s70 offen offset:1792 nt
  v_mov_b32_dpp v120, v64 quad_perm:[0,0,0,0] row_mask:0xf bank_mask:0xf
  v_mov_b32_dpp v121, v66 quad_perm:[2,2,2,2] row_mask:0xf bank_mask:0xf
  v_dot2_f32_bf16 v52, v48, v16, 0
  v_dot2_f32_bf16 v53, v48, v17, 0
  v_add_f32_dpp v120, v65, v120 quad_perm:[1,1,1,1] row_mask:0xf bank_mask:0xf
  v_add_f32_dpp v121, v67, v121 quad_perm:[3,3,3,3] row_mask:0xf bank_mask:0xf
  v_dot2_f32_bf16 v54, v49, v18, 0
  v_dot2_f32_bf16 v55, v49, v19, 0
  v_add_f32 v74, v120, v121
  v_dot2_f32_bf16 v56, v50, v20, 0
  v_dot2_f32_bf16 v57, v50, v21, 0
  v_dot2_f32_bf16 v58, v51, v22, 0
  v_dot2_f32_bf16 v59, v51, v23, 0
  v_cvt_pk_bf16_f32 v60, v52, v53
  v_cvt_pk_bf16_f32 v61, v54, v55
  v_cvt_pk_bf16_f32 v62, v56, v57
  v_cvt_pk_bf16_f32 v63, v58, v59
  s_nop 1
  v_mfma_f32_16x16x32_bf16 v[68:71], v[60:63], v[4:7], 0
  s_waitcnt vmcnt(16)
  v_cvt_f32_i32 v224, v224
  v_cvt_f32_i32 v225, v225
  v_cvt_f32_i32 v226, v226
  v_cvt_f32_i32 v227, v227
  v_cvt_f32_i32 v228, v228
  v_cvt_f32_i32 v229, v229
  v_cvt_f32_i32 v230, v230
  v_cvt_f32_i32 v231, v231
  v_pk_add_f32 v[224:225], v[224:225], v[8:9] neg_lo:[0,1] neg_hi:[0,1]
  v_pk_add_f32 v[226:227], v[226:227], v[10:11] neg_lo:[0,1] neg_hi:[0,1]
  v_pk_add_f32 v[228:229], v[228:229], v[12:13] neg_lo:[0,1] neg_hi:[0,1]
  v_pk_add_f32 v[230:231], v[230:231], v[14:15] neg_lo:[0,1] neg_hi:[0,1]
  v_cvt_pk_bf16_f32 v48, v224, v225
  v_cvt_pk_bf16_f32 v49, v226, v227
  v_cvt_pk_bf16_f32 v50, v228, v229
  v_cvt_pk_bf16_f32 v51, v230, v231
  buffer_load_dwordx4 v[160:163], v2, s[40:43], s70 offen offset:2048 nt
  buffer_load_dwordx4 v[164:167], v2, s[40:43], s70 offen offset:2560 nt
  v_mov_b32_dpp v120, v68 quad_perm:[0,0,0,0] row_mask:0xf bank_mask:0xf
  v_mov_b32_dpp v121, v70 quad_perm:[2,2,2,2] row_mask:0xf bank_mask:0xf
  v_dot2_f32_bf16 v52, v48, v16, 0
  v_dot2_f32_bf16 v53, v48, v17, 0
  v_add_f32_dpp v120, v69, v120 quad_perm:[1,1,1,1] row_mask:0xf bank_mask:0xf
  v_add_f32_dpp v121, v71, v121 quad_perm:[3,3,3,3] row_mask:0xf bank_mask:0xf
  v_dot2_f32_bf16 v54, v49, v18, 0
  v_dot2_f32_bf16 v55, v49, v19, 0
  v_add_f32 v75, v120, v121
  v_dot2_f32_bf16 v56, v50, v20, 0
  v_dot2_f32_bf16 v57, v50, v21, 0
  v_dot2_f32_bf16 v58, v51, v22, 0
  v_dot2_f32_bf16 v59, v51, v23, 0
  v_cvt_pk_bf16_f32 v60, v52, v53
  v_cvt_pk_bf16_f32 v61, v54, v55
  v_cvt_pk_bf16_f32 v62, v56, v57
  v_cvt_pk_bf16_f32 v63, v58, v59
  s_nop 1
  v_mfma_f32_16x16x32_bf16 v[64:67], v[60:63], v[4:7], 0
  s_waitcnt vmcnt(16)
  v_cvt_f32_i32 v232, v232
  v_cvt_f32_i32 v233, v233
  v_cvt_f32_i32 v234, v234
  v_cvt_f32_i32 v235, v235
  v_cvt_f32_i32 v236, v236
  v_cvt_f32_i32 v237, v237
  v_cvt_f32_i32 v238, v238
  v_cvt_f32_i32 v239, v239
  v_pk_add_f32 v[232:233], v[232:233], v[8:9] neg_lo:[0,1] neg_hi:[0,1]
  v_pk_add_f32 v[234:235], v[234:235], v[10:11] neg_lo:[0,1] neg_hi:[0,1]
  v_pk_add_f32 v[236:237], v[236:237], v[12:13] neg_lo:[0,1] neg_hi:[0,1]
  v_pk_add_f32 v[238:239], v[238:239], v[14:15] neg_lo:[0,1] neg_hi:[0,1]
  v_cvt_pk_bf16_f32 v48, v232, v233
  v_cvt_pk_bf16_f32 v49, v234, v235
  v_cvt_pk_bf16_f32 v50, v236, v237
  v_cvt_pk_bf16_f32 v51, v238, v239
  buffer_load_dwordx4 v[168:171], v2, s[40:43], s70 offen offset:2304 nt
  buffer_load_dwordx4 v[172:175], v2, s[40:43], s70 offen offset:2816 nt
  v_mov_b32_dpp v120, v64 quad_perm:[0,0,0,0] row_mask:0xf bank_mask:0xf
  v_mov_b32_dpp v121, v66 quad_perm:[2,2,2,2] row_mask:0xf bank_mask:0xf
  v_dot2_f32_bf16 v52, v48, v16, 0
  v_dot2_f32_bf16 v53, v48, v17, 0
  v_add_f32_dpp v120, v65, v120 quad_perm:[1,1,1,1] row_mask:0xf bank_mask:0xf
  v_add_f32_dpp v121, v67, v121 quad_perm:[3,3,3,3] row_mask:0xf bank_mask:0xf
  v_dot2_f32_bf16 v54, v49, v18, 0
  v_dot2_f32_bf16 v55, v49, v19, 0
  v_add_f32 v76, v120, v121
  v_dot2_f32_bf16 v56, v50, v20, 0
  v_dot2_f32_bf16 v57, v50, v21, 0
  v_dot2_f32_bf16 v58, v51, v22, 0
  v_dot2_f32_bf16 v59, v51, v23, 0
  v_cvt_pk_bf16_f32 v60, v52, v53
  v_cvt_pk_bf16_f32 v61, v54, v55
  v_cvt_pk_bf16_f32 v62, v56, v57
  v_cvt_pk_bf16_f32 v63, v58, v59
  s_nop 1
  v_mfma_f32_16x16x32_bf16 v[68:71], v[60:63], v[4:7], 0
  s_waitcnt vmcnt(16)
  v_cvt_f32_i32 v240, v240
  v_cvt_f32_i32 v241, v241
  v_cvt_f32_i32 v242, v242
  v_cvt_f32_i32 v243, v243
  v_cvt_f32_i32 v244, v244
  v_cvt_f32_i32 v245, v245
  v_cvt_f32_i32 v246, v246
  v_cvt_f32_i32 v247, v247
  v_pk_add_f32 v[240:241], v[240:241], v[8:9] neg_lo:[0,1] neg_hi:[0,1]
  v_pk_add_f32 v[242:243], v[242:243], v[10:11] neg_lo:[0,1] neg_hi:[0,1]
  v_pk_add_f32 v[244:245], v[244:245], v[12:13] neg_lo:[0,1] neg_hi:[0,1]
  v_pk_add_f32 v[246:247], v[246:247], v[14:15] neg_lo:[0,1] neg_hi:[0,1]
  v_cvt_pk_bf16_f32 v48, v240, v241
  v_cvt_pk_bf16_f32 v49, v242, v243
  v_cvt_pk_bf16_f32 v50, v244, v245
  v_cvt_pk_bf16_f32 v51, v246, v247
  buffer_load_dwordx4 v[176:179], v2, s[40:43], s70 offen offset:3072 nt
  buffer_load_dwordx4 v[180:183], v2, s[40:43], s70 offen offset:3584 nt
  v_mov_b32_dpp v120, v68 quad_perm:[0,0,0,0] row_mask:0xf bank_mask:0xf
  v_mov_b32_dpp v121, v70 quad_perm:[2,2,2,2] row_mask:0xf bank_mask:0xf
  v_dot2_f32_bf16 v52, v48, v16, 0
  v_dot2_f32_bf16 v53, v48, v17, 0
  v_add_f32_dpp v120, v69, v120 quad_perm:[1,1,1,1] row_mask:0xf bank_mask:0xf
  v_add_f32_dpp v121, v71, v121 quad_perm:[3,3,3,3] row_mask:0xf bank_mask:0xf
  v_dot2_f32_bf16 v54, v49, v18, 0
  v_dot2_f32_bf16 v55, v49, v19, 0
  v_add_f32 v77, v120, v121
  v_dot2_f32_bf16 v56, v50, v20, 0
  v_dot2_f32_bf16 v57, v50, v21, 0
  v_dot2_f32_bf16 v58, v51, v22, 0
  v_dot2_f32_bf16 v59, v51, v23, 0
  v_cvt_pk_bf16_f32 v60, v52, v53
  v_cvt_pk_bf16_f32 v61, v54, v55
  v_cvt_pk_bf16_f32 v62, v56, v57
  v_cvt_pk_bf16_f32 v63, v58, v59
  s_nop 1
  v_mfma_f32_16x16x32_bf16 v[64:67], v[60:63], v[4:7], 0
  s_waitcnt vmcnt(16)
  v_cvt_f32_i32 v248, v248
  v_cvt_f32_i32 v249, v249
  v_cvt_f32_i32 v250, v250
  v_cvt_f32_i32 v251, v251
  v_cvt_f32_i32 v252, v252
  v_cvt_f32_i32 v253, v253
  v_cvt_f32_i32 v254, v254
  v_cvt_f32_i32 v255, v255
  v_pk_add_f32 v[248:249], v[248:249], v[8:9] neg_lo:[0,1] neg_hi:[0,1]
  v_pk_add_f32 v[250:251], v[250:251], v[10:11] neg_lo:[0,1] neg_hi:[0,1]
  v_pk_add_f32 v[252:253], v[252:253], v[12:13] neg_lo:[0,1] neg_hi:[0,1]
  v_pk_add_f32 v[254:255], v[254:255], v[14:15] neg_lo:[0,1] neg_hi:[0,1]
  v_cvt_pk_bf16_f32 v48, v248, v249
  v_cvt_pk_bf16_f32 v49, v250, v251
  v_cvt_pk_bf16_f32 v50, v252, v253
  v_cvt_pk_bf16_f32 v51, v254, v255
  buffer_load_dwordx4 v[184:187], v2, s[40:43], s70 offen offset:3328 nt
  buffer_load_dwordx4 v[188:191], v2, s[40:43], s70 offen offset:3840 nt
  v_mov_b32_dpp v120, v64 quad_perm:[0,0,0,0] row_mask:0xf bank_mask:0xf
  v_mov_b32_dpp v121, v66 quad_perm:[2,2,2,2] row_mask:0xf bank_mask:0xf
  v_dot2_f32_bf16 v52, v48, v16, 0
  v_dot2_f32_bf16 v53, v48, v17, 0
  v_add_f32_dpp v120, v65, v120 quad_perm:[1,1,1,1] row_mask:0xf bank_mask:0xf
  v_add_f32_dpp v121, v67, v121 quad_perm:[3,3,3,3] row_mask:0xf bank_mask:0xf
  v_dot2_f32_bf16 v54, v49, v18, 0
  v_dot2_f32_bf16 v55, v49, v19, 0
  v_add_f32 v78, v120, v121
  v_dot2_f32_bf16 v56, v50, v20, 0
  v_dot2_f32_bf16 v57, v50, v21, 0
  v_dot2_f32_bf16 v58, v51, v22, 0
  v_dot2_f32_bf16 v59, v51, v23, 0
  v_cvt_pk_bf16_f32 v60, v52, v53
  v_cvt_pk_bf16_f32 v61, v54, v55
  v_cvt_pk_bf16_f32 v62, v56, v57
  v_cvt_pk_bf16_f32 v63, v58, v59
  s_nop 1
  v_mfma_f32_16x16x32_bf16 v[68:71], v[60:63], v[4:7], 0
  v_bfe_u32 v118, v0, 2, 1
  v_cvt_pk_bf16_f32 v48, v72, v73
  v_cvt_pk_bf16_f32 v49, v74, v75
  v_cvt_pk_bf16_f32 v50, v76, v77
  v_lshl_add_u32 v118, v118, 6, v3
  v_lshlrev_b32 v72, 16, v48
  v_and_b32 v73, s68, v48
  v_lshlrev_b32 v74, 16, v49
  v_and_b32 v75, s68, v49
  v_lshlrev_b32 v76, 16, v50
  v_and_b32 v77, s68, v50
  v_mov_b32_dpp v120, v68 quad_perm:[0,0,0,0] row_mask:0xf bank_mask:0xf
  v_mov_b32_dpp v121, v70 quad_perm:[2,2,2,2] row_mask:0xf bank_mask:0xf
  v_mul_f32 v72, s67, v72
  v_mul_f32 v73, s67, v73
  v_add_f32_dpp v120, v69, v120 quad_perm:[1,1,1,1] row_mask:0xf bank_mask:0xf
  v_add_f32_dpp v121, v71, v121 quad_perm:[3,3,3,3] row_mask:0xf bank_mask:0xf
  v_mul_f32 v74, s67, v74
  v_mul_f32 v75, s67, v75
  v_mul_f32 v76, s67, v76
  v_mul_f32 v77, s67, v77
  v_add_f32 v79, v120, v121
  v_cvt_pk_bf16_f32 v51, v78, v79
  v_cvt_pk_bf16_f32 v48, v72, v73
  v_cvt_pk_bf16_f32 v49, v74, v75
  v_cvt_pk_bf16_f32 v50, v76, v77
  v_lshlrev_b32 v78, 16, v51
  v_and_b32 v79, s68, v51
  v_add_u32 v118, s48, v118
  v_mul_f32 v78, s67, v78
  v_mul_f32 v79, s67, v79
  s_add_u32 s48, s48, 128
  v_cvt_pk_bf16_f32 v51, v78, v79
  s_mov_b64 exec, s[50:51]
  ds_write_b128 v118, v[48:51]
  s_mov_b64 exec, -1
  v_max3_f32 v116, v72, v73, v116
  v_max3_f32 v116, v74, v75, v116
  v_max3_f32 v116, v76, v77, v116
  v_max3_f32 v116, v78, v79, v116
  s_mov_b32 s72, s70
  s_add_u32 s32, s72, 0x20000
  s_and_b32 s32, s32, 0x1e0000
  s_andn2_b32 s73, s72, 0x1e0000
  s_or_b32 s32, s32, s73
  s_add_u32 s33, s29, 1
  s_mov_b32 s29, 0
  v_cvt_pk_bf16_f32 v118, v116, v116
  v_and_b32 v118, s68, v118
  v_mov_b32 v119, v118
  s_nop 1
  v_permlane16_swap_b32 v118, v119
  v_max_f32 v118, v118, v119
  v_mov_b32 v119, v118
  s_nop 1
  v_permlane32_swap_b32 v118, v119
  v_max_f32 v116, v118, v119
.p2align 6
L_B:
  s_waitcnt vmcnt(16) lgkmcnt(0)
  v_lshlrev_b32 v32, 16, v28
  v_and_b32 v34, s68, v28
  v_and_b32 v33, 0xffff, v24
  v_and_b32 v35, s68, v24
  v_lshlrev_b32 v36, 16, v29
  v_and_b32 v38, s68, v29
  v_and_b32 v37, 0xffff, v25
  v_and_b32 v39, s68, v25
  v_lshlrev_b32 v40, 16, v30
  v_and_b32 v42, s68, v30
  v_and_b32 v41, 0xffff, v26
  v_and_b32 v43, s68, v26
  v_lshlrev_b32 v44, 16, v31
  v_and_b32 v46, s68, v31
  v_and_b32 v45, 0xffff, v27
  v_and_b32 v47, s68, v27
  v_lshlrev_b32 v72, 16, v122
  v_and_b32 v73, s68, v122
  v_lshlrev_b32 v74, 16, v123
  v_and_b32 v75, s68, v123
  v_lshlrev_b32 v76, 16, v124
  v_and_b32 v77, s68, v124
  v_lshlrev_b32 v78, 16, v125
  v_and_b32 v79, s68, v125
  v_bfe_u32 v118, v0, 2, 1
  s_lshr_b32 s4, s32, 8
  v_lshl_add_u32 v118, v118, 6, v3
  buffer_load_dwordx4 v[24:27], v3, s[52:55], s4 offen nt
  v_add_u32 v118, s49, v118
  buffer_load_dwordx4 v[28:31], v3, s[56:59], s4 offen nt
  ds_read_b128 v[122:125], v118
  s_add_u32 s49, s49, 128
  v_sub_f32 v72, v72, v116
  v_sub_f32 v73, v73, v116
  v_sub_f32 v74, v74, v116
  v_sub_f32 v75, v75, v116
  v_sub_f32 v76, v76, v116
  v_sub_f32 v77, v77, v116
  v_sub_f32 v78, v78, v116
  v_sub_f32 v79, v79, v116
  v_mul_f32 v72, s66, v72
  v_mul_f32 v73, s66, v73
  v_mul_f32 v74, s66, v74
  v_mul_f32 v75, s66, v75
  v_mul_f32 v76, s66, v76
  v_mul_f32 v77, s66, v77
  v_mul_f32 v78, s66, v78
  v_mul_f32 v79, s66, v79
  v_exp_f32 v72, v72
  v_exp_f32 v73, v73
  v_exp_f32 v74, v74
  v_exp_f32 v75, v75
  v_exp_f32 v76, v76
  v_exp_f32 v77, v77
  v_exp_f32 v78, v78
  v_exp_f32 v79, v79
  s_nop 0
  v_cvt_pk_bf16_f32 v80, v72, v73
  v_cvt_pk_bf16_f32 v81, v74, v75
  v_cvt_pk_bf16_f32 v82, v76, v77
  v_cvt_pk_bf16_f32 v83, v78, v79
  v_add_f32 v118, v72, v73
  v_add_f32 v119, v74, v75
  v_add_f32 v120, v76, v77
  v_add_f32 v121, v78, v79
  v_add_f32 v118, v118, v119
  v_add_f32 v120, v120, v121
  v_add_f32 v118, v118, v120
  v_add_f32 v117, v117, v118
  s_waitcnt vmcnt(16)
  v_cvt_f32_i32 v128, v128
  v_cvt_f32_i32 v129, v129
  v_cvt_f32_i32 v130, v130
  v_cvt_f32_i32 v131, v131
  v_cvt_f32_i32 v132, v132
  v_cvt_f32_i32 v133, v133
  v_cvt_f32_i32 v134, v134
  v_cvt_f32_i32 v135, v135
  v_pk_add_f32 v[128:129], v[128:129], v[32:33] op_sel_hi:[1,0] neg_lo:[0,1] neg_hi:[0,1]
  v_pk_add_f32 v[130:131], v[130:131], v[32:33] op_sel_hi:[1,0] neg_lo:[0,1] neg_hi:[0,1]
  v_pk_add_f32 v[132:133], v[132:133], v[34:35] op_sel_hi:[1,0] neg_lo:[0,1] neg_hi:[0,1]
  v_pk_add_f32 v[134:135], v[134:135], v[34:35] op_sel_hi:[1,0] neg_lo:[0,1] neg_hi:[0,1]
  v_cvt_pk_bf16_f32 v48, v128, v132
  v_cvt_pk_bf16_f32 v49, v129, v133
  v_cvt_pk_bf16_f32 v50, v130, v134
  v_cvt_pk_bf16_f32 v51, v131, v135
  buffer_load_dwordx4 v[192:195], v2, s[40:43], s32 offen offset:0 nt
  buffer_load_dwordx4 v[196:199], v2, s[40:43], s32 offen offset:512 nt
  v_dot2_f32_bf16 v52, v48, v33, 0
  v_dot2_f32_bf16 v53, v48, v35, 0
  v_dot2_f32_bf16 v54, v49, v33, 0
  v_dot2_f32_bf16 v55, v49, v35, 0
  v_dot2_f32_bf16 v56, v50, v33, 0
  v_dot2_f32_bf16 v57, v50, v35, 0
  v_dot2_f32_bf16 v58, v51, v33, 0
  v_dot2_f32_bf16 v59, v51, v35, 0
  v_cvt_pk_bf16_f32 v60, v52, v53
  v_cvt_pk_bf16_f32 v64, v54, v55
  v_cvt_pk_bf16_f32 v68, v56, v57
  v_cvt_pk_bf16_f32 v72, v58, v59
  s_waitcnt vmcnt(16)
  v_cvt_f32_i32 v136, v136
  v_cvt_f32_i32 v137, v137
  v_cvt_f32_i32 v138, v138
  v_cvt_f32_i32 v139, v139
  v_cvt_f32_i32 v140, v140
  v_cvt_f32_i32 v141, v141
  v_cvt_f32_i32 v142, v142
  v_cvt_f32_i32 v143, v143
  v_pk_add_f32 v[136:137], v[136:137], v[32:33] op_sel_hi:[1,0] neg_lo:[0,1] neg_hi:[0,1]
  v_pk_add_f32 v[138:139], v[138:139], v[32:33] op_sel_hi:[1,0] neg_lo:[0,1] neg_hi:[0,1]
  v_pk_add_f32 v[140:141], v[140:141], v[34:35] op_sel_hi:[1,0] neg_lo:[0,1] neg_hi:[0,1]
  v_pk_add_f32 v[142:143], v[142:143], v[34:35] op_sel_hi:[1,0] neg_lo:[0,1] neg_hi:[0,1]
  v_cvt_pk_bf16_f32 v48, v136, v140
  v_cvt_pk_bf16_f32 v49, v137, v141
  v_cvt_pk_bf16_f32 v50, v138, v142
  v_cvt_pk_bf16_f32 v51, v139, v143
  buffer_load_dwordx4 v[200:203], v2, s[40:43], s32 offen offset:256 nt
  buffer_load_dwordx4 v[204:207], v2, s[40:43], s32 offen offset:768 nt
  v_dot2_f32_bf16 v52, v48, v33, 0
  v_dot2_f32_bf16 v53, v48, v35, 0
  v_dot2_f32_bf16 v54, v49, v33, 0
  v_dot2_f32_bf16 v55, v49, v35, 0
  v_dot2_f32_bf16 v56, v50, v33, 0
  v_dot2_f32_bf16 v57, v50, v35, 0
  v_dot2_f32_bf16 v58, v51, v33, 0
  v_dot2_f32_bf16 v59, v51, v35, 0
  v_cvt_pk_bf16_f32 v128, v52, v53
  v_cvt_pk_bf16_f32 v132, v54, v55
  v_cvt_pk_bf16_f32 v136, v56, v57
  v_cvt_pk_bf16_f32 v140, v58, v59
  s_waitcnt vmcnt(16)
  v_cvt_f32_i32 v144, v144
  v_cvt_f32_i32 v145, v145
  v_cvt_f32_i32 v146, v146
  v_cvt_f32_i32 v147, v147
  v_cvt_f32_i32 v148, v148
  v_cvt_f32_i32 v149, v149
  v_cvt_f32_i32 v150, v150
  v_cvt_f32_i32 v151, v151
  v_pk_add_f32 v[144:145], v[144:145], v[36:37] op_sel_hi:[1,0] neg_lo:[0,1] neg_hi:[0,1]
  v_pk_add_f32 v[146:147], v[146:147], v[36:37] op_sel_hi:[1,0] neg_lo:[0,1] neg_hi:[0,1]
  v_pk_add_f32 v[148:149], v[148:149], v[38:39] op_sel_hi:[1,0] neg_lo:[0,1] neg_hi:[0,1]
  v_pk_add_f32 v[150:151], v[150:151], v[38:39] op_sel_hi:[1,0] neg_lo:[0,1] neg_hi:[0,1]
  v_cvt_pk_bf16_f32 v48, v144, v148
  v_cvt_pk_bf16_f32 v49, v145, v149
  v_cvt_pk_bf16_f32 v50, v146, v150
  v_cvt_pk_bf16_f32 v51, v147, v151
  buffer_load_dwordx4 v[208:211], v2, s[40:43], s32 offen offset:1024 nt
  buffer_load_dwordx4 v[212:215], v2, s[40:43], s32 offen offset:1536 nt
  v_dot2_f32_bf16 v52, v48, v37, 0
  v_dot2_f32_bf16 v53, v48, v39, 0
  v_dot2_f32_bf16 v54, v49, v37, 0
  v_dot2_f32_bf16 v55, v49, v39, 0
  v_dot2_f32_bf16 v56, v50, v37, 0
  v_dot2_f32_bf16 v57, v50, v39, 0
  v_dot2_f32_bf16 v58, v51, v37, 0
  v_dot2_f32_bf16 v59, v51, v39, 0
  v_cvt_pk_bf16_f32 v61, v52, v53
  v_cvt_pk_bf16_f32 v65, v54, v55
  v_cvt_pk_bf16_f32 v69, v56, v57
  v_cvt_pk_bf16_f32 v73, v58, v59
  s_waitcnt vmcnt(16)
  v_cvt_f32_i32 v152, v152
  v_cvt_f32_i32 v153, v153
  v_cvt_f32_i32 v154, v154
  v_cvt_f32_i32 v155, v155
  v_cvt_f32_i32 v156, v156
  v_cvt_f32_i32 v157, v157
  v_cvt_f32_i32 v158, v158
  v_cvt_f32_i32 v159, v159
  v_pk_add_f32 v[152:153], v[152:153], v[36:37] op_sel_hi:[1,0] neg_lo:[0,1] neg_hi:[0,1]
  v_pk_add_f32 v[154:155], v[154:155], v[36:37] op_sel_hi:[1,0] neg_lo:[0,1] neg_hi:[0,1]
  v_pk_add_f32 v[156:157], v[156:157], v[38:39] op_sel_hi:[1,0] neg_lo:[0,1] neg_hi:[0,1]
  v_pk_add_f32 v[158:159], v[158:159], v[38:39] op_sel_hi:[1,0] neg_lo:[0,1] neg_hi:[0,1]
  v_cvt_pk_bf16_f32 v48, v152, v156
  v_cvt_pk_bf16_f32 v49, v153, v157
  v_cvt_pk_bf16_f32 v50, v154, v158
  v_cvt_pk_bf16_f32 v51, v155, v159
  buffer_load_dwordx4 v[216:219], v2, s[40:43], s32 offen offset:1280 nt
  buffer_load_dwordx4 v[220:223], v2, s[40:43], s32 offen offset:1792 nt
  v_dot2_f32_bf16 v52, v48, v37, 0
  v_dot2_f32_bf16 v53, v48, v39, 0
  v_dot2_f32_bf16 v54, v49, v37, 0
  v_dot2_f32_bf16 v55, v49, v39, 0
  v_dot2_f32_bf16 v56, v50, v37, 0
  v_dot2_f32_bf16 v57, v50, v39, 0
  v_dot2_f32_bf16 v58, v51, v37, 0
  v_dot2_f32_bf16 v59, v51, v39, 0
  v_cvt_pk_bf16_f32 v129, v52, v53
  v_cvt_pk_bf16_f32 v133, v54, v55
  v_cvt_pk_bf16_f32 v137, v56, v57
  v_cvt_pk_bf16_f32 v141, v58, v59
  s_waitcnt vmcnt(16)
  v_cvt_f32_i32 v160, v160
  v_cvt_f32_i32 v161, v161
  v_cvt_f32_i32 v162, v162
  v_cvt_f32_i32 v163, v163
  v_cvt_f32_i32 v164, v164
  v_cvt_f32_i32 v165, v165
  v_cvt_f32_i32 v166, v166
  v_cvt_f32_i32 v167, v167
  v_pk_add_f32 v[160:161], v[160:161], v[40:41] op_sel_hi:[1,0] neg_lo:[0,1] neg_hi:[0,1]
  v_pk_add_f32 v[162:163], v[162:163], v[40:41] op_sel_hi:[1,0] neg_lo:[0,1] neg_hi:[0,1]
  v_pk_add_f32 v[164:165], v[164:165], v[42:43] op_sel_hi:[1,0] neg_lo:[0,1] neg_hi:[0,1]
  v_pk_add_f32 v[166:167], v[166:167], v[42:43] op_sel_hi:[1,0] neg_lo:[0,1] neg_hi:[0,1]
  v_cvt_pk_bf16_f32 v48, v160, v164
  v_cvt_pk_bf16_f32 v49, v161, v165
  v_cvt_pk_bf16_f32 v50, v162, v166
  v_cvt_pk_bf16_f32 v51, v163, v167
  buffer_load_dwordx4 v[224:227], v2, s[40:43], s32 offen offset:2048 nt
  buffer_load_dwordx4 v[228:231], v2, s[40:43], s32 offen offset:2560 nt
  v_dot2_f32_bf16 v52, v48, v41, 0
  v_dot2_f32_bf16 v53, v48, v43, 0
  v_dot2_f32_bf16 v54, v49, v41, 0
  v_dot2_f32_bf16 v55, v49, v43, 0
  v_dot2_f32_bf16 v56, v50, v41, 0
  v_dot2_f32_bf16 v57, v50, v43, 0
  v_dot2_f32_bf16 v58, v51, v41, 0
  v_dot2_f32_bf16 v59, v51, v43, 0
  v_cvt_pk_bf16_f32 v62, v52, v53
  v_cvt_pk_bf16_f32 v66, v54, v55
  v_cvt_pk_bf16_f32 v70, v56, v57
  v_cvt_pk_bf16_f32 v74, v58, v59
  s_waitcnt vmcnt(16)
  v_cvt_f32_i32 v168, v168
  v_cvt_f32_i32 v169, v169
  v_cvt_f32_i32 v170, v170
  v_cvt_f32_i32 v171, v171
  v_cvt_f32_i32 v172, v172
  v_cvt_f32_i32 v173, v173
  v_cvt_f32_i32 v174, v174
  v_cvt_f32_i32 v175, v175
  v_pk_add_f32 v[168:169], v[168:169], v[40:41] op_sel_hi:[1,0] neg_lo:[0,1] neg_hi:[0,1]
  v_pk_add_f32 v[170:171], v[170:171], v[40:41] op_sel_hi:[1,0] neg_lo:[0,1] neg_hi:[0,1]
  v_pk_add_f32 v[172:173], v[172:173], v[42:43] op_sel_hi:[1,0] neg_lo:[0,1] neg_hi:[0,1]
  v_pk_add_f32 v[174:175], v[174:175], v[42:43] op_sel_hi:[1,0] neg_lo:[0,1] neg_hi:[0,1]
  v_cvt_pk_bf16_f32 v48, v168, v172
  v_cvt_pk_bf16_f32 v49, v169, v173
  v_cvt_pk_bf16_f32 v50, v170, v174
  v_cvt_pk_bf16_f32 v51, v171, v175
  buffer_load_dwordx4 v[232:235], v2, s[40:43], s32 offen offset:2304 nt
  buffer_load_dwordx4 v[236:239], v2, s[40:43], s32 offen offset:2816 nt
  v_dot2_f32_bf16 v52, v48, v41, 0
  v_dot2_f32_bf16 v53, v48, v43, 0
  v_dot2_f32_bf16 v54, v49, v41, 0
  v_dot2_f32_bf16 v55, v49, v43, 0
  v_dot2_f32_bf16 v56, v50, v41, 0
  v_dot2_f32_bf16 v57, v50, v43, 0
  v_dot2_f32_bf16 v58, v51, v41, 0
  v_dot2_f32_bf16 v59, v51, v43, 0
  v_cvt_pk_bf16_f32 v130, v52, v53
  v_cvt_pk_bf16_f32 v134, v54, v55
  v_cvt_pk_bf16_f32 v138, v56, v57
  v_cvt_pk_bf16_f32 v142, v58, v59
  s_waitcnt vmcnt(16)
  v_cvt_f32_i32 v176, v176
  v_cvt_f32_i32 v177, v177
  v_cvt_f32_i32 v178, v178
  v_cvt_f32_i32 v179, v179
  v_cvt_f32_i32 v180, v180
  v_cvt_f32_i32 v181, v181
  v_cvt_f32_i32 v182, v182
  v_cvt_f32_i32 v183, v183
  v_pk_add_f32 v[176:177], v[176:177], v[44:45] op_sel_hi:[1,0] neg_lo:[0,1] neg_hi:[0,1]
  v_pk_add_f32 v[178:179], v[178:179], v[44:45] op_sel_hi:[1,0] neg_lo:[0,1] neg_hi:[0,1]
  v_pk_add_f32 v[180:181], v[180:181], v[46:47] op_sel_hi:[1,0] neg_lo:[0,1] neg_hi:[0,1]
  v_pk_add_f32 v[182:183], v[182:183], v[46:47] op_sel_hi:[1,0] neg_lo:[0,1] neg_hi:[0,1]
  v_cvt_pk_bf16_f32 v48, v176, v180
  v_cvt_pk_bf16_f32 v49, v177, v181
  v_cvt_pk_bf16_f32 v50, v178, v182
  v_cvt_pk_bf16_f32 v51, v179, v183
  buffer_load_dwordx4 v[240:243], v2, s[40:43], s32 offen offset:3072 nt
  buffer_load_dwordx4 v[244:247], v2, s[40:43], s32 offen offset:3584 nt
  v_dot2_f32_bf16 v52, v48, v45, 0
  v_dot2_f32_bf16 v53, v48, v47, 0
  v_dot2_f32_bf16 v54, v49, v45, 0
  v_dot2_f32_bf16 v55, v49, v47, 0
  v_dot2_f32_bf16 v56, v50, v45, 0
  v_dot2_f32_bf16 v57, v50, v47, 0
  v_dot2_f32_bf16 v58, v51, v45, 0
  v_dot2_f32_bf16 v59, v51, v47, 0
  v_cvt_pk_bf16_f32 v63, v52, v53
  v_cvt_pk_bf16_f32 v67, v54, v55
  v_cvt_pk_bf16_f32 v71, v56, v57
  v_cvt_pk_bf16_f32 v75, v58, v59
  s_nop 1
  v_mfma_f32_16x16x32_bf16 v[84:87], v[80:83], v[60:63], v[84:87]
  v_mfma_f32_16x16x32_bf16 v[88:91], v[80:83], v[64:67], v[88:91]
  v_mfma_f32_16x16x32_bf16 v[92:95], v[80:83], v[68:71], v[92:95]
  v_mfma_f32_16x16x32_bf16 v[96:99], v[80:83], v[72:75], v[96:99]
  s_waitcnt vmcnt(16)
  v_cvt_f32_i32 v184, v184
  v_cvt_f32_i32 v185, v185
  v_cvt_f32_i32 v186, v186
  v_cvt_f32_i32 v187, v187
  v_cvt_f32_i32 v188, v188
  v_cvt_f32_i32 v189, v189
  v_cvt_f32_i32 v190, v190
  v_cvt_f32_i32 v191, v191
  v_pk_add_f32 v[184:185], v[184:185], v[44:45] op_sel_hi:[1,0] neg_lo:[0,1] neg_hi:[0,1]
  v_pk_add_f32 v[186:187], v[186:187], v[44:45] op_sel_hi:[1,0] neg_lo:[0,1] neg_hi:[0,1]
  v_pk_add_f32 v[188:189], v[188:189], v[46:47] op_sel_hi:[1,0] neg_lo:[0,1] neg_hi:[0,1]
  v_pk_add_f32 v[190:191], v[190:191], v[46:47] op_sel_hi:[1,0] neg_lo:[0,1] neg_hi:[0,1]
  v_cvt_pk_bf16_f32 v48, v184, v188
  v_cvt_pk_bf16_f32 v49, v185, v189
  v_cvt_pk_bf16_f32 v50, v186, v190
  v_cvt_pk_bf16_f32 v51, v187, v191
  buffer_load_dwordx4 v[248:251], v2, s[40:43], s32 offen offset:3328 nt
  buffer_load_dwordx4 v[252:255], v2, s[40:43], s32 offen offset:3840 nt
  v_dot2_f32_bf16 v52, v48, v45, 0
  v_dot2_f32_bf16 v53, v48, v47, 0
  v_dot2_f32_bf16 v54, v49, v45, 0
  v_dot2_f32_bf16 v55, v49, v47, 0
  v_dot2_f32_bf16 v56, v50, v45, 0
  v_dot2_f32_bf16 v57, v50, v47, 0
  v_dot2_f32_bf16 v58, v51, v45, 0
  v_dot2_f32_bf16 v59, v51, v47, 0
  v_cvt_pk_bf16_f32 v131, v52, v53
  v_cvt_pk_bf16_f32 v135, v54, v55
  v_cvt_pk_bf16_f32 v139, v56, v57
  v_cvt_pk_bf16_f32 v143, v58, v59
  s_nop 1
  v_mfma_f32_16x16x32_bf16 v[100:103], v[80:83], v[128:131], v[100:103]
  v_mfma_f32_16x16x32_bf16 v[104:107], v[80:83], v[132:135], v[104:107]
  v_mfma_f32_16x16x32_bf16 v[108:111], v[80:83], v[136:139], v[108:111]
  v_mfma_f32_16x16x32_bf16 v[112:115], v[80:83], v[140:143], v[112:115]
  s_waitcnt vmcnt(16) lgkmcnt(0)
  v_lshlrev_b32 v32, 16, v28
  v_and_b32 v34, s68, v28
  v_and_b32 v33, 0xffff, v24
  v_and_b32 v35, s68, v24
  v_lshlrev_b32 v36, 16, v29
  v_and_b32 v38, s68, v29
  v_and_b32 v37, 0xffff, v25
  v_and_b32 v39, s68, v25
  v_lshlrev_b32 v40, 16, v30
  v_and_b32 v42, s68, v30
  v_and_b32 v41, 0xffff, v26
  v_and_b32 v43, s68, v26
  v_lshlrev_b32 v44, 16, v31
  v_and_b32 v46, s68, v31
  v_and_b32 v45, 0xffff, v27
  v_and_b32 v47, s68, v27
  v_lshlrev_b32 v72, 16, v122
  v_and_b32 v73, s68, v122
  v_lshlrev_b32 v74, 16, v123
  v_and_b32 v75, s68, v123
  v_lshlrev_b32 v76, 16, v124
  v_and_b32 v77, s68, v124
  v_lshlrev_b32 v78, 16, v125
  v_and_b32 v79, s68, v125
  v_sub_f32 v72, v72, v116
  v_sub_f32 v73, v73, v116
  v_sub_f32 v74, v74, v116
  v_sub_f32 v75, v75, v116
  v_sub_f32 v76, v76, v116
  v_sub_f32 v77, v77, v116
  v_sub_f32 v78, v78, v116
  v_sub_f32 v79, v79, v116
  v_mul_f32 v72, s66, v72
  v_mul_f32 v73, s66, v73
  v_mul_f32 v74, s66, v74
  v_mul_f32 v75, s66, v75
  v_mul_f32 v76, s66, v76
  v_mul_f32 v77, s66, v77
  v_mul_f32 v78, s66, v78
  v_mul_f32 v79, s66, v79
  v_exp_f32 v72, v72
  v_exp_f32 v73, v73
  v_exp_f32 v74, v74
  v_exp_f32 v75, v75
  v_exp_f32 v76, v76
  v_exp_f32 v77, v77
  v_exp_f32 v78, v78
  v_exp_f32 v79, v79
  s_nop 0
  v_cvt_pk_bf16_f32 v80, v72, v73
  v_cvt_pk_bf16_f32 v81, v74, v75
  v_cvt_pk_bf16_f32 v82, v76, v77
  v_cvt_pk_bf16_f32 v83, v78, v79
  v_add_f32 v118, v72, v73
  v_add_f32 v119, v74, v75
  v_add_f32 v120, v76, v77
  v_add_f32 v121, v78, v79
  v_add_f32 v118, v118, v119
  v_add_f32 v120, v120, v121
  v_add_f32 v118, v118, v120
  v_add_f32 v117, v117, v118
  s_add_u32 s70, s29, 1
  s_cmp_lt_u32 s70, s33
  s_cbranch_scc0 L_dyn
  s_lshl_b32 s71, s29, 2
  v_mov_b32 v119, s71
  ds_read_b32 v119, v119 offset:28676
  s_barrier
  s_cmp_eq_u32 s80, 0
  s_cbranch_scc1 L_Bnext
  s_cmp_eq_u32 s29, s8
  s_cbranch_scc0 L_Bs2
  s_lshl_b32 s71, s26, 2
  s_add_u32 s71, s71, 128
  v_mov_b32 v127, 1
  s_mov_b64 exec, 1
  buffer_atomic_add v127, off, s[76:79], s71 sc0 sc1
  s_mov_b64 exec, -1
L_Bs2:
  s_add_u32 s70, s29, 2
  s_cmp_eq_u32 s70, s33
  s_cbranch_scc0 L_Bnext
  s_cmp_eq_u32 s74, 0
  s_cbranch_scc1 L_Bnext
  v_mov_b32 v126, 1
  s_mov_b64 exec, 1
  buffer_atomic_add v126, off, s[60:63], s9 sc0 sc1
  s_mov_b64 exec, -1
L_Bnext:
  s_waitcnt lgkmcnt(0)
  v_readfirstlane_b32 s28, v119
  s_lshr_b32 s70, s28, 3
  s_lshl_b32 s70, s70, 1
  s_add_u32 s70, s70, s26
  s_and_b32 s70, s70, 15
  s_lshl_b32 s70, s70, 3
  s_and_b32 s71, s28, 7
  s_lshl_b32 s71, s71, 7
  s_add_u32 s70, s70, s71
  s_add_u32 s70, s70, s27
  s_lshl_b32 s70, s70, 14
  v_bfe_u32 v118, v0, 2, 1
  s_lshr_b32 s4, s70, 8
  v_lshl_add_u32 v118, v118, 6, v3
  buffer_load_dwordx4 v[24:27], v3, s[52:55], s4 offen nt
  v_add_u32 v118, s49, v118
  buffer_load_dwordx4 v[28:31], v3, s[56:59], s4 offen nt
  ds_read_b128 v[122:125], v118
  s_add_u32 s49, s49, 128
  s_waitcnt vmcnt(16)
  v_cvt_f32_i32 v192, v192
  v_cvt_f32_i32 v193, v193
  v_cvt_f32_i32 v194, v194
  v_cvt_f32_i32 v195, v195
  v_cvt_f32_i32 v196, v196
  v_cvt_f32_i32 v197, v197
  v_cvt_f32_i32 v198, v198
  v_cvt_f32_i32 v199, v199
  v_pk_add_f32 v[192:193], v[192:193], v[32:33] op_sel_hi:[1,0] neg_lo:[0,1] neg_hi:[0,1]
  v_pk_add_f32 v[194:195], v[194:195], v[32:33] op_sel_hi:[1,0] neg_lo:[0,1] neg_hi:[0,1]
  v_pk_add_f32 v[196:197], v[196:197], v[34:35] op_sel_hi:[1,0] neg_lo:[0,1] neg_hi:[0,1]
  v_pk_add_f32 v[198:199], v[198:199], v[34:35] op_sel_hi:[1,0] neg_lo:[0,1] neg_hi:[0,1]
  v_cvt_pk_bf16_f32 v48, v192, v196
  v_cvt_pk_bf16_f32 v49, v193, v197
  v_cvt_pk_bf16_f32 v50, v194, v198
  v_cvt_pk_bf16_f32 v51, v195, v199
  buffer_load_dwordx4 v[128:131], v2, s[40:43], s70 offen offset:0 nt
  buffer_load_dwordx4 v[132:135], v2, s[40:43], s70 offen offset:512 nt
  v_dot2_f32_bf16 v52, v48, v33, 0
  v_dot2_f32_bf16 v53, v48, v35, 0
  v_dot2_f32_bf16 v54, v49, v33, 0
  v_dot2_f32_bf16 v55, v49, v35, 0
  v_dot2_f32_bf16 v56, v50, v33, 0
  v_dot2_f32_bf16 v57, v50, v35, 0
  v_dot2_f32_bf16 v58, v51, v33, 0
  v_dot2_f32_bf16 v59, v51, v35, 0
  v_cvt_pk_bf16_f32 v60, v52, v53
  v_cvt_pk_bf16_f32 v64, v54, v55
  v_cvt_pk_bf16_f32 v68, v56, v57
  v_cvt_pk_bf16_f32 v72, v58, v59
  s_waitcnt vmcnt(16)
  v_cvt_f32_i32 v200, v200
  v_cvt_f32_i32 v201, v201
  v_cvt_f32_i32 v202, v202
  v_cvt_f32_i32 v203, v203
  v_cvt_f32_i32 v204, v204
  v_cvt_f32_i32 v205, v205
  v_cvt_f32_i32 v206, v206
  v_cvt_f32_i32 v207, v207
  v_pk_add_f32 v[200:201], v[200:201], v[32:33] op_sel_hi:[1,0] neg_lo:[0,1] neg_hi:[0,1]
  v_pk_add_f32 v[202:203], v[202:203], v[32:33] op_sel_hi:[1,0] neg_lo:[0,1] neg_hi:[0,1]
  v_pk_add_f32 v[204:205], v[204:205], v[34:35] op_sel_hi:[1,0] neg_lo:[0,1] neg_hi:[0,1]
  v_pk_add_f32 v[206:207], v[206:207], v[34:35] op_sel_hi:[1,0] neg_lo:[0,1] neg_hi:[0,1]
  v_cvt_pk_bf16_f32 v48, v200, v204
  v_cvt_pk_bf16_f32 v49, v201, v205
  v_cvt_pk_bf16_f32 v50, v202, v206
  v_cvt_pk_bf16_f32 v51, v203, v207
  buffer_load_dwordx4 v[136:139], v2, s[40:43], s70 offen offset:256 nt
  buffer_load_dwordx4 v[140:143], v2, s[40:43], s70 offen offset:768 nt
  v_dot2_f32_bf16 v52, v48, v33, 0
  v_dot2_f32_bf16 v53, v48, v35, 0
  v_dot2_f32_bf16 v54, v49, v33, 0
  v_dot2_f32_bf16 v55, v49, v35, 0
  v_dot2_f32_bf16 v56, v50, v33, 0
  v_dot2_f32_bf16 v57, v50, v35, 0
  v_dot2_f32_bf16 v58, v51, v33, 0
  v_dot2_f32_bf16 v59, v51, v35, 0
  v_cvt_pk_bf16_f32 v192, v52, v53
  v_cvt_pk_bf16_f32 v196, v54, v55
  v_cvt_pk_bf16_f32 v200, v56, v57
  v_cvt_pk_bf16_f32 v204, v58, v59
  s_waitcnt vmcnt(16)
  v_cvt_f32_i32 v208, v208
  v_cvt_f32_i32 v209, v209
  v_cvt_f32_i32 v210, v210
  v_cvt_f32_i32 v211, v211
  v_cvt_f32_i32 v212, v212
  v_cvt_f32_i32 v213, v213
  v_cvt_f32_i32 v214, v214
  v_cvt_f32_i32 v215, v215
  v_pk_add_f32 v[208:209], v[208:209], v[36:37] op_sel_hi:[1,0] neg_lo:[0,1] neg_hi:[0,1]
  v_pk_add_f32 v[210:211], v[210:211], v[36:37] op_sel_hi:[1,0] neg_lo:[0,1] neg_hi:[0,1]
  v_pk_add_f32 v[212:213], v[212:213], v[38:39] op_sel_hi:[1,0] neg_lo:[0,1] neg_hi:[0,1]
  v_pk_add_f32 v[214:215], v[214:215], v[38:39] op_sel_hi:[1,0] neg_lo:[0,1] neg_hi:[0,1]
  v_cvt_pk_bf16_f32 v48, v208, v212
  v_cvt_pk_bf16_f32 v49, v209, v213
  v_cvt_pk_bf16_f32 v50, v210, v214
  v_cvt_pk_bf16_f32 v51, v211, v215
  buffer_load_dwordx4 v[144:147], v2, s[40:43], s70 offen offset:1024 nt
  buffer_load_dwordx4 v[148:151], v2, s[40:43], s70 offen offset:1536 nt
  v_dot2_f32_bf16 v52, v48, v37, 0
  v_dot2_f32_bf16 v53, v48, v39, 0
  v_dot2_f32_bf16 v54, v49, v37, 0
  v_dot2_f32_bf16 v55, v49, v39, 0
  v_dot2_f32_bf16 v56, v50, v37, 0
  v_dot2_f32_bf16 v57, v50, v39, 0
  v_dot2_f32_bf16 v58, v51, v37, 0
  v_dot2_f32_bf16 v59, v51, v39, 0
  v_cvt_pk_bf16_f32 v61, v52, v53
  v_cvt_pk_bf16_f32 v65, v54, v55
  v_cvt_pk_bf16_f32 v69, v56, v57
  v_cvt_pk_bf16_f32 v73, v58, v59
  s_waitcnt vmcnt(16)
  v_cvt_f32_i32 v216, v216
  v_cvt_f32_i32 v217, v217
  v_cvt_f32_i32 v218, v218
  v_cvt_f32_i32 v219, v219
  v_cvt_f32_i32 v220, v220
  v_cvt_f32_i32 v221, v221
  v_cvt_f32_i32 v222, v222
  v_cvt_f32_i32 v223, v223
  v_pk_add_f32 v[216:217], v[216:217], v[36:37] op_sel_hi:[1,0] neg_lo:[0,1] neg_hi:[0,1]
  v_pk_add_f32 v[218:219], v[218:219], v[36:37] op_sel_hi:[1,0] neg_lo:[0,1] neg_hi:[0,1]
  v_pk_add_f32 v[220:221], v[220:221], v[38:39] op_sel_hi:[1,0] neg_lo:[0,1] neg_hi:[0,1]
  v_pk_add_f32 v[222:223], v[222:223], v[38:39] op_sel_hi:[1,0] neg_lo:[0,1] neg_hi:[0,1]
  v_cvt_pk_bf16_f32 v48, v216, v220
  v_cvt_pk_bf16_f32 v49, v217, v221
  v_cvt_pk_bf16_f32 v50, v218, v222
  v_cvt_pk_bf16_f32 v51, v219, v223
  buffer_load_dwordx4 v[152:155], v2, s[40:43], s70 offen offset:1280 nt
  buffer_load_dwordx4 v[156:159], v2, s[40:43], s70 offen offset:1792 nt
  v_dot2_f32_bf16 v52, v48, v37, 0
  v_dot2_f32_bf16 v53, v48, v39, 0
  v_dot2_f32_bf16 v54, v49, v37, 0
  v_dot2_f32_bf16 v55, v49, v39, 0
  v_dot2_f32_bf16 v56, v50, v37, 0
  v_dot2_f32_bf16 v57, v50, v39, 0
  v_dot2_f32_bf16 v58, v51, v37, 0
  v_dot2_f32_bf16 v59, v51, v39, 0
  v_cvt_pk_bf16_f32 v193, v52, v53
  v_cvt_pk_bf16_f32 v197, v54, v55
  v_cvt_pk_bf16_f32 v201, v56, v57
  v_cvt_pk_bf16_f32 v205, v58, v59
  s_waitcnt vmcnt(16)
  v_cvt_f32_i32 v224, v224
  v_cvt_f32_i32 v225, v225
  v_cvt_f32_i32 v226, v226
  v_cvt_f32_i32 v227, v227
  v_cvt_f32_i32 v228, v228
  v_cvt_f32_i32 v229, v229
  v_cvt_f32_i32 v230, v230
  v_cvt_f32_i32 v231, v231
  v_pk_add_f32 v[224:225], v[224:225], v[40:41] op_sel_hi:[1,0] neg_lo:[0,1] neg_hi:[0,1]
  v_pk_add_f32 v[226:227], v[226:227], v[40:41] op_sel_hi:[1,0] neg_lo:[0,1] neg_hi:[0,1]
  v_pk_add_f32 v[228:229], v[228:229], v[42:43] op_sel_hi:[1,0] neg_lo:[0,1] neg_hi:[0,1]
  v_pk_add_f32 v[230:231], v[230:231], v[42:43] op_sel_hi:[1,0] neg_lo:[0,1] neg_hi:[0,1]
  v_cvt_pk_bf16_f32 v48, v224, v228
  v_cvt_pk_bf16_f32 v49, v225, v229
  v_cvt_pk_bf16_f32 v50, v226, v230
  v_cvt_pk_bf16_f32 v51, v227, v231
  buffer_load_dwordx4 v[160:163], v2, s[40:43], s70 offen offset:2048 nt
  buffer_load_dwordx4 v[164:167], v2, s[40:43], s70 offen offset:2560 nt
  v_dot2_f32_bf16 v52, v48, v41, 0
  v_dot2_f32_bf16 v53, v48, v43, 0
  v_dot2_f32_bf16 v54, v49, v41, 0
  v_dot2_f32_bf16 v55, v49, v43, 0
  v_dot2_f32_bf16 v56, v50, v41, 0
  v_dot2_f32_bf16 v57, v50, v43, 0
  v_dot2_f32_bf16 v58, v51, v41, 0
  v_dot2_f32_bf16 v59, v51, v43, 0
  v_cvt_pk_bf16_f32 v62, v52, v53
  v_cvt_pk_bf16_f32 v66, v54, v55
  v_cvt_pk_bf16_f32 v70, v56, v57
  v_cvt_pk_bf16_f32 v74, v58, v59
  s_waitcnt vmcnt(16)
  v_cvt_f32_i32 v232, v232
  v_cvt_f32_i32 v233, v233
  v_cvt_f32_i32 v234, v234
  v_cvt_f32_i32 v235, v235
  v_cvt_f32_i32 v236, v236
  v_cvt_f32_i32 v237, v237
  v_cvt_f32_i32 v238, v238
  v_cvt_f32_i32 v239, v239
  v_pk_add_f32 v[232:233], v[232:233], v[40:41] op_sel_hi:[1,0] neg_lo:[0,1] neg_hi:[0,1]
  v_pk_add_f32 v[234:235], v[234:235], v[40:41] op_sel_hi:[1,0] neg_lo:[0,1] neg_hi:[0,1]
  v_pk_add_f32 v[236:237], v[236:237], v[42:43] op_sel_hi:[1,0] neg_lo:[0,1] neg_hi:[0,1]
  v_pk_add_f32 v[238:239], v[238:239], v[42:43] op_sel_hi:[1,0] neg_lo:[0,1] neg_hi:[0,1]
  v_cvt_pk_bf16_f32 v48, v232, v236
  v_cvt_pk_bf16_f32 v49, v233, v237
  v_cvt_pk_bf16_f32 v50, v234, v238
  v_cvt_pk_bf16_f32 v51, v235, v239
  buffer_load_dwordx4 v[168:171], v2, s[40:43], s70 offen offset:2304 nt
  buffer_load_dwordx4 v[172:175], v2, s[40:43], s70 offen offset:2816 nt
  v_dot2_f32_bf16 v52, v48, v41, 0
  v_dot2_f32_bf16 v53, v48, v43, 0
  v_dot2_f32_bf16 v54, v49, v41, 0
  v_dot2_f32_bf16 v55, v49, v43, 0
  v_dot2_f32_bf16 v56, v50, v41, 0
  v_dot2_f32_bf16 v57, v50, v43, 0
  v_dot2_f32_bf16 v58, v51, v41, 0
  v_dot2_f32_bf16 v59, v51, v43, 0
  v_cvt_pk_bf16_f32 v194, v52, v53
  v_cvt_pk_bf16_f32 v198, v54, v55
  v_cvt_pk_bf16_f32 v202, v56, v57
  v_cvt_pk_bf16_f32 v206, v58, v59
  s_waitcnt vmcnt(16)
  v_cvt_f32_i32 v240, v240
  v_cvt_f32_i32 v241, v241
  v_cvt_f32_i32 v242, v242
  v_cvt_f32_i32 v243, v243
  v_cvt_f32_i32 v244, v244
  v_cvt_f32_i32 v245, v245
  v_cvt_f32_i32 v246, v246
  v_cvt_f32_i32 v247, v247
  v_pk_add_f32 v[240:241], v[240:241], v[44:45] op_sel_hi:[1,0] neg_lo:[0,1] neg_hi:[0,1]
  v_pk_add_f32 v[242:243], v[242:243], v[44:45] op_sel_hi:[1,0] neg_lo:[0,1] neg_hi:[0,1]
  v_pk_add_f32 v[244:245], v[244:245], v[46:47] op_sel_hi:[1,0] neg_lo:[0,1] neg_hi:[0,1]
  v_pk_add_f32 v[246:247], v[246:247], v[46:47] op_sel_hi:[1,0] neg_lo:[0,1] neg_hi:[0,1]
  v_cvt_pk_bf16_f32 v48, v240, v244
  v_cvt_pk_bf16_f32 v49, v241, v245
  v_cvt_pk_bf16_f32 v50, v242, v246
  v_cvt_pk_bf16_f32 v51, v243, v247
  buffer_load_dwordx4 v[176:179], v2, s[40:43], s70 offen offset:3072 nt
  buffer_load_dwordx4 v[180:183], v2, s[40:43], s70 offen offset:3584 nt
  v_dot2_f32_bf16 v52, v48, v45, 0
  v_dot2_f32_bf16 v53, v48, v47, 0
  v_dot2_f32_bf16 v54, v49, v45, 0
  v_dot2_f32_bf16 v55, v49, v47, 0
  v_dot2_f32_bf16 v56, v50, v45, 0
  v_dot2_f32_bf16 v57, v50, v47, 0
  v_dot2_f32_bf16 v58, v51, v45, 0
  v_dot2_f32_bf16 v59, v51, v47, 0
  v_cvt_pk_bf16_f32 v63, v52, v53
  v_cvt_pk_bf16_f32 v67, v54, v55
  v_cvt_pk_bf16_f32 v71, v56, v57
  v_cvt_pk_bf16_f32 v75, v58, v59
  s_nop 1
  v_mfma_f32_16x16x32_bf16 v[84:87], v[80:83], v[60:63], v[84:87]
  v_mfma_f32_16x16x32_bf16 v[88:91], v[80:83], v[64:67], v[88:91]
  v_mfma_f32_16x16x32_bf16 v[92:95], v[80:83], v[68:71], v[92:95]
  v_mfma_f32_16x16x32_bf16 v[96:99], v[80:83], v[72:75], v[96:99]
  s_waitcnt vmcnt(16)
  v_cvt_f32_i32 v248, v248
  v_cvt_f32_i32 v249, v249
  v_cvt_f32_i32 v250, v250
  v_cvt_f32_i32 v251, v251
  v_cvt_f32_i32 v252, v252
  v_cvt_f32_i32 v253, v253
  v_cvt_f32_i32 v254, v254
  v_cvt_f32_i32 v255, v255
  v_pk_add_f32 v[248:249], v[248:249], v[44:45] op_sel_hi:[1,0] neg_lo:[0,1] neg_hi:[0,1]
  v_pk_add_f32 v[250:251], v[250:251], v[44:45] op_sel_hi:[1,0] neg_lo:[0,1] neg_hi:[0,1]
  v_pk_add_f32 v[252:253], v[252:253], v[46:47] op_sel_hi:[1,0] neg_lo:[0,1] neg_hi:[0,1]
  v_pk_add_f32 v[254:255], v[254:255], v[46:47] op_sel_hi:[1,0] neg_lo:[0,1] neg_hi:[0,1]
  v_cvt_pk_bf16_f32 v48, v248, v252
  v_cvt_pk_bf16_f32 v49, v249, v253
  v_cvt_pk_bf16_f32 v50, v250, v254
  v_cvt_pk_bf16_f32 v51, v251, v255
  buffer_load_dwordx4 v[184:187], v2, s[40:43], s70 offen offset:3328 nt
  buffer_load_dwordx4 v[188:191], v2, s[40:43], s70 offen offset:3840 nt
  v_dot2_f32_bf16 v52, v48, v45, 0
  v_dot2_f32_bf16 v53, v48, v47, 0
  v_dot2_f32_bf16 v54, v49, v45, 0
  v_dot2_f32_bf16 v55, v49, v47, 0
  v_dot2_f32_bf16 v56, v50, v45, 0
  v_dot2_f32_bf16 v57, v50, v47, 0
  v_dot2_f32_bf16 v58, v51, v45, 0
  v_dot2_f32_bf16 v59, v51, v47, 0
  v_cvt_pk_bf16_f32 v195, v52, v53
  v_cvt_pk_bf16_f32 v199, v54, v55
  v_cvt_pk_bf16_f32 v203, v56, v57
  v_cvt_pk_bf16_f32 v207, v58, v59
  s_nop 1
  v_mfma_f32_16x16x32_bf16 v[100:103], v[80:83], v[192:195], v[100:103]
  v_mfma_f32_16x16x32_bf16 v[104:107], v[80:83], v[196:199], v[104:107]
  v_mfma_f32_16x16x32_bf16 v[108:111], v[80:83], v[200:203], v[108:111]
  v_mfma_f32_16x16x32_bf16 v[112:115], v[80:83], v[204:207], v[112:115]
  s_mov_b32 s72, s70
  s_add_u32 s32, s72, 0x20000
  s_and_b32 s32, s32, 0x1e0000
  s_andn2_b32 s73, s72, 0x1e0000
  s_or_b32 s32, s32, s73
  s_add_u32 s29, s29, 1
  s_branch L_B
.p2align 6
L_loop:
  s_cmp_eq_u32 s30, 0
  s_cbranch_scc1 L_idle
  buffer_load_dwordx4 v[24:27], v3, s[52:55], s73 offen nt
  buffer_load_dwordx4 v[28:31], v3, s[56:59], s73 offen nt
  s_waitcnt vmcnt(16)
  v_cvt_f32_i32 v128, v128
  v_cvt_f32_i32 v129, v129
  v_cvt_f32_i32 v130, v130
  v_cvt_f32_i32 v131, v131
  v_cvt_f32_i32 v132, v132
  v_cvt_f32_i32 v133, v133
  v_cvt_f32_i32 v134, v134
  v_cvt_f32_i32 v135, v135
  v_pk_add_f32 v[128:129], v[128:129], v[8:9] neg_lo:[0,1] neg_hi:[0,1]
  v_pk_add_f32 v[130:131], v[130:131], v[10:11] neg_lo:[0,1] neg_hi:[0,1]
  v_pk_add_f32 v[132:133], v[132:133], v[12:13] neg_lo:[0,1] neg_hi:[0,1]
  v_pk_add_f32 v[134:135], v[134:135], v[14:15] neg_lo:[0,1] neg_hi:[0,1]
  v_cvt_pk_bf16_f32 v48, v128, v129
  v_cvt_pk_bf16_f32 v49, v130, v131
  v_cvt_pk_bf16_f32 v50, v132, v133
  v_cvt_pk_bf16_f32 v51, v134, v135
  buffer_load_dwordx4 v[192:195], v2, s[40:43], s72 offen offset:0 nt
  buffer_load_dwordx4 v[196:199], v2, s[40:43], s72 offen offset:512 nt
  v_dot2_f32_bf16 v52, v48, v16, 0
  v_dot2_f32_bf16 v53, v48, v17, 0
  v_dot2_f32_bf16 v54, v49, v18, 0
  v_dot2_f32_bf16 v55, v49, v19, 0
  v_dot2_f32_bf16 v56, v50, v20, 0
  v_dot2_f32_bf16 v57, v50, v21, 0
  v_dot2_f32_bf16 v58, v51, v22, 0
  v_dot2_f32_bf16 v59, v51, v23, 0
  v_cvt_pk_bf16_f32 v60, v52, v53
  v_cvt_pk_bf16_f32 v61, v54, v55
  v_cvt_pk_bf16_f32 v62, v56, v57
  v_cvt_pk_bf16_f32 v63, v58, v59
  s_nop 1
  v_mfma_f32_16x16x32_bf16 v[64:67], v[60:63], v[4:7], 0
  s_waitcnt vmcnt(16)
  v_cvt_f32_i32 v136, v136
  v_cvt_f32_i32 v137, v137
  v_cvt_f32_i32 v138, v138
  v_cvt_f32_i32 v139, v139
  v_cvt_f32_i32 v140, v140
  v_cvt_f32_i32 v141, v141
  v_cvt_f32_i32 v142, v142
  v_cvt_f32_i32 v143, v143
  v_pk_add_f32 v[136:137], v[136:137], v[8:9] neg_lo:[0,1] neg_hi:[0,1]
  v_pk_add_f32 v[138:139], v[138:139], v[10:11] neg_lo:[0,1] neg_hi:[0,1]
  v_pk_add_f32 v[140:141], v[140:141], v[12:13] neg_lo:[0,1] neg_hi:[0,1]
  v_pk_add_f32 v[142:143], v[142:143], v[14:15] neg_lo:[0,1] neg_hi:[0,1]
  v_cvt_pk_bf16_f32 v48, v136, v137
  v_cvt_pk_bf16_f32 v49, v138, v139
  v_cvt_pk_bf16_f32 v50, v140, v141
  v_cvt_pk_bf16_f32 v51, v142, v143
  buffer_load_dwordx4 v[200:203], v2, s[40:43], s72 offen offset:256 nt
  buffer_load_dwordx4 v[204:207], v2, s[40:43], s72 offen offset:768 nt
  v_mov_b32_dpp v120, v64 quad_perm:[0,0,0,0] row_mask:0xf bank_mask:0xf
  v_mov_b32_dpp v121, v66 quad_perm:[2,2,2,2] row_mask:0xf bank_mask:0xf
  v_dot2_f32_bf16 v52, v48, v16, 0
  v_dot2_f32_bf16 v53, v48, v17, 0
  v_add_f32_dpp v120, v65, v120 quad_perm:[1,1,1,1] row_mask:0xf bank_mask:0xf
  v_add_f32_dpp v121, v67, v121 quad_perm:[3,3,3,3] row_mask:0xf bank_mask:0xf
  v_dot2_f32_bf16 v54, v49, v18, 0
  v_dot2_f32_bf16 v55, v49, v19, 0
  v_add_f32 v72, v120, v121
  v_dot2_f32_bf16 v56, v50, v20, 0
  v_dot2_f32_bf16 v57, v50, v21, 0
  v_dot2_f32_bf16 v58, v51, v22, 0
  v_dot2_f32_bf16 v59, v51, v23, 0
  v_cvt_pk_bf16_f32 v60, v52, v53
  v_cvt_pk_bf16_f32 v61, v54, v55
  v_cvt_pk_bf16_f32 v62, v56, v57
  v_cvt_pk_bf16_f32 v63, v58, v59
  s_nop 1
  v_mfma_f32_16x16x32_bf16 v[68:71], v[60:63], v[4:7], 0
  s_waitcnt vmcnt(16)
  v_cvt_f32_i32 v144, v144
  v_cvt_f32_i32 v145, v145
  v_cvt_f32_i32 v146, v146
  v_cvt_f32_i32 v147, v147
  v_cvt_f32_i32 v148, v148
  v_cvt_f32_i32 v149, v149
  v_cvt_f32_i32 v150, v150
  v_cvt_f32_i32 v151, v151
  v_pk_add_f32 v[144:145], v[144:145], v[8:9] neg_lo:[0,1] neg_hi:[0,1]
  v_pk_add_f32 v[146:147], v[146:147], v[10:11] neg_lo:[0,1] neg_hi:[0,1]
  v_pk_add_f32 v[148:149], v[148:149], v[12:13] neg_lo:[0,1] neg_hi:[0,1]
  v_pk_add_f32 v[150:151], v[150:151], v[14:15] neg_lo:[0,1] neg_hi:[0,1]
  v_cvt_pk_bf16_f32 v48, v144, v145
  v_cvt_pk_bf16_f32 v49, v146, v147
  v_cvt_pk_bf16_f32 v50, v148, v149
  v_cvt_pk_bf16_f32 v51, v150, v151
  buffer_load_dwordx4 v[208:211], v2, s[40:43], s72 offen offset:1024 nt
  buffer_load_dwordx4 v[212:215], v2, s[40:43], s72 offen offset:1536 nt
  v_mov_b32_dpp v120, v68 quad_perm:[0,0,0,0] row_mask:0xf bank_mask:0xf
  v_mov_b32_dpp v121, v70 quad_perm:[2,2,2,2] row_mask:0xf bank_mask:0xf
  v_dot2_f32_bf16 v52, v48, v16, 0
  v_dot2_f32_bf16 v53, v48, v17, 0
  v_add_f32_dpp v120, v69, v120 quad_perm:[1,1,1,1] row_mask:0xf bank_mask:0xf
  v_add_f32_dpp v121, v71, v121 quad_perm:[3,3,3,3] row_mask:0xf bank_mask:0xf
  v_dot2_f32_bf16 v54, v49, v18, 0
  v_dot2_f32_bf16 v55, v49, v19, 0
  v_add_f32 v73, v120, v121
  v_dot2_f32_bf16 v56, v50, v20, 0
  v_dot2_f32_bf16 v57, v50, v21, 0
  v_dot2_f32_bf16 v58, v51, v22, 0
  v_dot2_f32_bf16 v59, v51, v23, 0
  v_cvt_pk_bf16_f32 v60, v52, v53
  v_cvt_pk_bf16_f32 v61, v54, v55
  v_cvt_pk_bf16_f32 v62, v56, v57
  v_cvt_pk_bf16_f32 v63, v58, v59
  s_nop 1
  v_mfma_f32_16x16x32_bf16 v[64:67], v[60:63], v[4:7], 0
  s_waitcnt vmcnt(16)
  v_cvt_f32_i32 v152, v152
  v_cvt_f32_i32 v153, v153
  v_cvt_f32_i32 v154, v154
  v_cvt_f32_i32 v155, v155
  v_cvt_f32_i32 v156, v156
  v_cvt_f32_i32 v157, v157
  v_cvt_f32_i32 v158, v158
  v_cvt_f32_i32 v159, v159
  v_pk_add_f32 v[152:153], v[152:153], v[8:9] neg_lo:[0,1] neg_hi:[0,1]
  v_pk_add_f32 v[154:155], v[154:155], v[10:11] neg_lo:[0,1] neg_hi:[0,1]
  v_pk_add_f32 v[156:157], v[156:157], v[12:13] neg_lo:[0,1] neg_hi:[0,1]
  v_pk_add_f32 v[158:159], v[158:159], v[14:15] neg_lo:[0,1] neg_hi:[0,1]
  v_cvt_pk_bf16_f32 v48, v152, v153
  v_cvt_pk_bf16_f32 v49, v154, v155
  v_cvt_pk_bf16_f32 v50, v156, v157
  v_cvt_pk_bf16_f32 v51, v158, v159
  buffer_load_dwordx4 v[216:219], v2, s[40:43], s72 offen offset:1280 nt
  buffer_load_dwordx4 v[220:223], v2, s[40:43], s72 offen offset:1792 nt
  v_mov_b32_dpp v120, v64 quad_perm:[0,0,0,0] row_mask:0xf bank_mask:0xf
  v_mov_b32_dpp v121, v66 quad_perm:[2,2,2,2] row_mask:0xf bank_mask:0xf
  v_dot2_f32_bf16 v52, v48, v16, 0
  v_dot2_f32_bf16 v53, v48, v17, 0
  v_add_f32_dpp v120, v65, v120 quad_perm:[1,1,1,1] row_mask:0xf bank_mask:0xf
  v_add_f32_dpp v121, v67, v121 quad_perm:[3,3,3,3] row_mask:0xf bank_mask:0xf
  v_dot2_f32_bf16 v54, v49, v18, 0
  v_dot2_f32_bf16 v55, v49, v19, 0
  v_add_f32 v74, v120, v121
  v_dot2_f32_bf16 v56, v50, v20, 0
  v_dot2_f32_bf16 v57, v50, v21, 0
  v_dot2_f32_bf16 v58, v51, v22, 0
  v_dot2_f32_bf16 v59, v51, v23, 0
  v_cvt_pk_bf16_f32 v60, v52, v53
  v_cvt_pk_bf16_f32 v61, v54, v55
  v_cvt_pk_bf16_f32 v62, v56, v57
  v_cvt_pk_bf16_f32 v63, v58, v59
  s_nop 1
  v_mfma_f32_16x16x32_bf16 v[68:71], v[60:63], v[4:7], 0
  s_waitcnt vmcnt(16)
  v_cvt_f32_i32 v160, v160
  v_cvt_f32_i32 v161, v161
  v_cvt_f32_i32 v162, v162
  v_cvt_f32_i32 v163, v163
  v_cvt_f32_i32 v164, v164
  v_cvt_f32_i32 v165, v165
  v_cvt_f32_i32 v166, v166
  v_cvt_f32_i32 v167, v167
  v_pk_add_f32 v[160:161], v[160:161], v[8:9] neg_lo:[0,1] neg_hi:[0,1]
  v_pk_add_f32 v[162:163], v[162:163], v[10:11] neg_lo:[0,1] neg_hi:[0,1]
  v_pk_add_f32 v[164:165], v[164:165], v[12:13] neg_lo:[0,1] neg_hi:[0,1]
  v_pk_add_f32 v[166:167], v[166:167], v[14:15] neg_lo:[0,1] neg_hi:[0,1]
  v_cvt_pk_bf16_f32 v48, v160, v161
  v_cvt_pk_bf16_f32 v49, v162, v163
  v_cvt_pk_bf16_f32 v50, v164, v165
  v_cvt_pk_bf16_f32 v51, v166, v167
  buffer_load_dwordx4 v[224:227], v2, s[40:43], s72 offen offset:2048 nt
  buffer_load_dwordx4 v[228:231], v2, s[40:43], s72 offen offset:2560 nt
  v_mov_b32_dpp v120, v68 quad_perm:[0,0,0,0] row_mask:0xf bank_mask:0xf
  v_mov_b32_dpp v121, v70 quad_perm:[2,2,2,2] row_mask:0xf bank_mask:0xf
  v_dot2_f32_bf16 v52, v48, v16, 0
  v_dot2_f32_bf16 v53, v48, v17, 0
  v_add_f32_dpp v120, v69, v120 quad_perm:[1,1,1,1] row_mask:0xf bank_mask:0xf
  v_add_f32_dpp v121, v71, v121 quad_perm:[3,3,3,3] row_mask:0xf bank_mask:0xf
  v_dot2_f32_bf16 v54, v49, v18, 0
  v_dot2_f32_bf16 v55, v49, v19, 0
  v_add_f32 v75, v120, v121
  v_dot2_f32_bf16 v56, v50, v20, 0
  v_dot2_f32_bf16 v57, v50, v21, 0
  v_dot2_f32_bf16 v58, v51, v22, 0
  v_dot2_f32_bf16 v59, v51, v23, 0
  v_cvt_pk_bf16_f32 v60, v52, v53
  v_cvt_pk_bf16_f32 v61, v54, v55
  v_cvt_pk_bf16_f32 v62, v56, v57
  v_cvt_pk_bf16_f32 v63, v58, v59
  s_nop 1
  v_mfma_f32_16x16x32_bf16 v[64:67], v[60:63], v[4:7], 0
  s_waitcnt vmcnt(16)
  v_cvt_f32_i32 v168, v168
  v_cvt_f32_i32 v169, v169
  v_cvt_f32_i32 v170, v170
  v_cvt_f32_i32 v171, v171
  v_cvt_f32_i32 v172, v172
  v_cvt_f32_i32 v173, v173
  v_cvt_f32_i32 v174, v174
  v_cvt_f32_i32 v175, v175
  v_pk_add_f32 v[168:169], v[168:169], v[8:9] neg_lo:[0,1] neg_hi:[0,1]
  v_pk_add_f32 v[170:171], v[170:171], v[10:11] neg_lo:[0,1] neg_hi:[0,1]
  v_pk_add_f32 v[172:173], v[172:173], v[12:13] neg_lo:[0,1] neg_hi:[0,1]
  v_pk_add_f32 v[174:175], v[174:175], v[14:15] neg_lo:[0,1] neg_hi:[0,1]
  v_cvt_pk_bf16_f32 v48, v168, v169
  v_cvt_pk_bf16_f32 v49, v170, v171
  v_cvt_pk_bf16_f32 v50, v172, v173
  v_cvt_pk_bf16_f32 v51, v174, v175
  buffer_load_dwordx4 v[232:235], v2, s[40:43], s72 offen offset:2304 nt
  buffer_load_dwordx4 v[236:239], v2, s[40:43], s72 offen offset:2816 nt
  v_mov_b32_dpp v120, v64 quad_perm:[0,0,0,0] row_mask:0xf bank_mask:0xf
  v_mov_b32_dpp v121, v66 quad_perm:[2,2,2,2] row_mask:0xf bank_mask:0xf
  v_dot2_f32_bf16 v52, v48, v16, 0
  v_dot2_f32_bf16 v53, v48, v17, 0
  v_add_f32_dpp v120, v65, v120 quad_perm:[1,1,1,1] row_mask:0xf bank_mask:0xf
  v_add_f32_dpp v121, v67, v121 quad_perm:[3,3,3,3] row_mask:0xf bank_mask:0xf
  v_dot2_f32_bf16 v54, v49, v18, 0
  v_dot2_f32_bf16 v55, v49, v19, 0
  v_add_f32 v76, v120, v121
  v_dot2_f32_bf16 v56, v50, v20, 0
  v_dot2_f32_bf16 v57, v50, v21, 0
  v_dot2_f32_bf16 v58, v51, v22, 0
  v_dot2_f32_bf16 v59, v51, v23, 0
  v_cvt_pk_bf16_f32 v60, v52, v53
  v_cvt_pk_bf16_f32 v61, v54, v55
  v_cvt_pk_bf16_f32 v62, v56, v57
  v_cvt_pk_bf16_f32 v63, v58, v59
  s_nop 1
  v_mfma_f32_16x16x32_bf16 v[68:71], v[60:63], v[4:7], 0
  s_waitcnt vmcnt(16)
  v_cvt_f32_i32 v176, v176
  v_cvt_f32_i32 v177, v177
  v_cvt_f32_i32 v178, v178
  v_cvt_f32_i32 v179, v179
  v_cvt_f32_i32 v180, v180
  v_cvt_f32_i32 v181, v181
  v_cvt_f32_i32 v182, v182
  v_cvt_f32_i32 v183, v183
  v_pk_add_f32 v[176:177], v[176:177], v[8:9] neg_lo:[0,1] neg_hi:[0,1]
  v_pk_add_f32 v[178:179], v[178:179], v[10:11] neg_lo:[0,1] neg_hi:[0,1]
  v_pk_add_f32 v[180:181], v[180:181], v[12:13] neg_lo:[0,1] neg_hi:[0,1]
  v_pk_add_f32 v[182:183], v[182:183], v[14:15] neg_lo:[0,1] neg_hi:[0,1]
  v_cvt_pk_bf16_f32 v48, v176, v177
  v_cvt_pk_bf16_f32 v49, v178, v179
  v_cvt_pk_bf16_f32 v50, v180, v181
  v_cvt_pk_bf16_f32 v51, v182, v183
  buffer_load_dwordx4 v[240:243], v2, s[40:43], s72 offen offset:3072 nt
  buffer_load_dwordx4 v[244:247], v2, s[40:43], s72 offen offset:3584 nt
  v_mov_b32_dpp v120, v68 quad_perm:[0,0,0,0] row_mask:0xf bank_mask:0xf
  v_mov_b32_dpp v121, v70 quad_perm:[2,2,2,2] row_mask:0xf bank_mask:0xf
  v_dot2_f32_bf16 v52, v48, v16, 0
  v_dot2_f32_bf16 v53, v48, v17, 0
  v_add_f32_dpp v120, v69, v120 quad_perm:[1,1,1,1] row_mask:0xf bank_mask:0xf
  v_add_f32_dpp v121, v71, v121 quad_perm:[3,3,3,3] row_mask:0xf bank_mask:0xf
  v_dot2_f32_bf16 v54, v49, v18, 0
  v_dot2_f32_bf16 v55, v49, v19, 0
  v_add_f32 v77, v120, v121
  v_dot2_f32_bf16 v56, v50, v20, 0
  v_dot2_f32_bf16 v57, v50, v21, 0
  v_dot2_f32_bf16 v58, v51, v22, 0
  v_dot2_f32_bf16 v59, v51, v23, 0
  v_cvt_pk_bf16_f32 v60, v52, v53
  v_cvt_pk_bf16_f32 v61, v54, v55
  v_cvt_pk_bf16_f32 v62, v56, v57
  v_cvt_pk_bf16_f32 v63, v58, v59
  s_nop 1
  v_mfma_f32_16x16x32_bf16 v[64:67], v[60:63], v[4:7], 0
  s_waitcnt vmcnt(16)
  v_cvt_f32_i32 v184, v184
  v_cvt_f32_i32 v185, v185
  v_cvt_f32_i32 v186, v186
  v_cvt_f32_i32 v187, v187
  v_cvt_f32_i32 v188, v188
  v_cvt_f32_i32 v189, v189
  v_cvt_f32_i32 v190, v190
  v_cvt_f32_i32 v191, v191
  v_pk_add_f32 v[184:185], v[184:185], v[8:9] neg_lo:[0,1] neg_hi:[0,1]
  v_pk_add_f32 v[186:187], v[186:187], v[10:11] neg_lo:[0,1] neg_hi:[0,1]
  v_pk_add_f32 v[188:189], v[188:189], v[12:13] neg_lo:[0,1] neg_hi:[0,1]
  v_pk_add_f32 v[190:191], v[190:191], v[14:15] neg_lo:[0,1] neg_hi:[0,1]
  v_cvt_pk_bf16_f32 v48, v184, v185
  v_cvt_pk_bf16_f32 v49, v186, v187
  v_cvt_pk_bf16_f32 v50, v188, v189
  v_cvt_pk_bf16_f32 v51, v190, v191
  buffer_load_dwordx4 v[248:251], v2, s[40:43], s72 offen offset:3328 nt
  buffer_load_dwordx4 v[252:255], v2, s[40:43], s72 offen offset:3840 nt
  v_mov_b32_dpp v120, v64 quad_perm:[0,0,0,0] row_mask:0xf bank_mask:0xf
  v_mov_b32_dpp v121, v66 quad_perm:[2,2,2,2] row_mask:0xf bank_mask:0xf
  v_dot2_f32_bf16 v52, v48, v16, 0
  v_dot2_f32_bf16 v53, v48, v17, 0
  v_add_f32_dpp v120, v65, v120 quad_perm:[1,1,1,1] row_mask:0xf bank_mask:0xf
  v_add_f32_dpp v121, v67, v121 quad_perm:[3,3,3,3] row_mask:0xf bank_mask:0xf
  v_dot2_f32_bf16 v54, v49, v18, 0
  v_dot2_f32_bf16 v55, v49, v19, 0
  v_add_f32 v78, v120, v121
  v_dot2_f32_bf16 v56, v50, v20, 0
  v_dot2_f32_bf16 v57, v50, v21, 0
  v_dot2_f32_bf16 v58, v51, v22, 0
  v_dot2_f32_bf16 v59, v51, v23, 0
  v_cvt_pk_bf16_f32 v60, v52, v53
  v_cvt_pk_bf16_f32 v61, v54, v55
  v_cvt_pk_bf16_f32 v62, v56, v57
  v_cvt_pk_bf16_f32 v63, v58, v59
  s_nop 1
  v_mfma_f32_16x16x32_bf16 v[68:71], v[60:63], v[4:7], 0
  s_waitcnt vmcnt(16)
  v_lshlrev_b32 v32, 16, v28
  v_and_b32 v34, s68, v28
  v_and_b32 v33, 0xffff, v24
  v_and_b32 v35, s68, v24
  v_lshlrev_b32 v36, 16, v29
  v_and_b32 v38, s68, v29
  v_and_b32 v37, 0xffff, v25
  v_and_b32 v39, s68, v25
  v_lshlrev_b32 v40, 16, v30
  v_and_b32 v42, s68, v30
  v_and_b32 v41, 0xffff, v26
  v_and_b32 v43, s68, v26
  v_lshlrev_b32 v44, 16, v31
  v_and_b32 v46, s68, v31
  v_and_b32 v45, 0xffff, v27
  v_and_b32 v47, s68, v27
  v_mov_b32_dpp v120, v68 quad_perm:[0,0,0,0] row_mask:0xf bank_mask:0xf
  v_mov_b32_dpp v121, v70 quad_perm:[2,2,2,2] row_mask:0xf bank_mask:0xf
  s_nop 1
  v_add_f32_dpp v120, v69, v120 quad_perm:[1,1,1,1] row_mask:0xf bank_mask:0xf
  v_add_f32_dpp v121, v71, v121 quad_perm:[3,3,3,3] row_mask:0xf bank_mask:0xf
  v_add_f32 v79, v120, v121
  v_cvt_pk_bf16_f32 v48, v72, v73
  v_cvt_pk_bf16_f32 v49, v74, v75
  v_cvt_pk_bf16_f32 v50, v76, v77
  v_cvt_pk_bf16_f32 v51, v78, v79
  v_lshlrev_b32 v72, 16, v48
  v_and_b32 v73, s68, v48
  v_lshlrev_b32 v74, 16, v49
  v_and_b32 v75, s68, v49
  v_lshlrev_b32 v76, 16, v50
  v_and_b32 v77, s68, v50
  v_lshlrev_b32 v78, 16, v51
  v_and_b32 v79, s68, v51
  v_mul_f32 v72, s67, v72
  v_mul_f32 v73, s67, v73
  v_mul_f32 v74, s67, v74
  v_mul_f32 v75, s67, v75
  v_mul_f32 v76, s67, v76
  v_mul_f32 v77, s67, v77
  v_mul_f32 v78, s67, v78
  v_mul_f32 v79, s67, v79
  v_cvt_pk_bf16_f32 v48, v72, v73
  v_cvt_pk_bf16_f32 v49, v74, v75
  v_cvt_pk_bf16_f32 v50, v76, v77
  v_cvt_pk_bf16_f32 v51, v78, v79
  v_lshlrev_b32 v72, 16, v48
  v_and_b32 v73, s68, v48
  v_lshlrev_b32 v74, 16, v49
  v_and_b32 v75, s68, v49
  v_lshlrev_b32 v76, 16, v50
  v_and_b32 v77, s68, v50
  v_lshlrev_b32 v78, 16, v51
  v_and_b32 v79, s68, v51
  v_max3_f32 v118, v72, v73, v74
  v_max3_f32 v119, v75, v76, v77
  v_max3_f32 v118, v78, v79, v118
  v_max_f32 v118, v118, v119
  v_mov_b32 v119, v118
  s_nop 1
  v_permlane16_swap_b32 v118, v119
  v_max_f32 v118, v118, v119
  v_mov_b32 v119, v118
  s_nop 1
  v_permlane32_swap_b32 v118, v119
  v_max_f32 v118, v118, v119
  v_cmp_gt_f32 vcc, v118, v116
  s_cbranch_vccz L_norescale
  v_max_f32 v118, v118, v116
  v_sub_f32 v119, v116, v118
  v_mul_f32 v119, s66, v119
  v_exp_f32 v119, v119
  v_mov_b32 v116, v118
  s_nop 0
  v_mul_f32 v117, v117, v119
  v_readlane_b32 s70, v119, 0
  v_readlane_b32 s71, v119, 4
  s_nop 1
  v_mov_b32 v120, s70
  v_mov_b32 v121, s71
  v_cndmask_b32 v120, v120, v121, s[64:65]
  v_mul_f32 v84, v84, v120
  v_mul_f32 v85, v85, v120
  v_mul_f32 v86, v86, v120
  v_mul_f32 v87, v87, v120
  v_mul_f32 v88, v88, v120
  v_mul_f32 v89, v89, v120
  v_mul_f32 v90, v90, v120
  v_mul_f32 v91, v91, v120
  v_mul_f32 v92, v92, v120
  v_mul_f32 v93, v93, v120
  v_mul_f32 v94, v94, v120
  v_mul_f32 v95, v95, v120
  v_mul_f32 v96, v96, v120
  v_mul_f32 v97, v97, v120
  v_mul_f32 v98, v98, v120
  v_mul_f32 v99, v99, v120
  v_mul_f32 v100, v100, v120
  v_mul_f32 v101, v101, v120
  v_mul_f32 v102, v102, v120
  v_mul_f32 v103, v103, v120
  v_mul_f32 v104, v104, v120
  v_mul_f32 v105, v105, v120
  v_mul_f32 v106, v106, v120
  v_mul_f32 v107, v107, v120
  v_mul_f32 v108, v108, v120
  v_mul_f32 v109, v109, v120
  v_mul_f32 v110, v110, v120
  v_mul_f32 v111, v111, v120
  v_mul_f32 v112, v112, v120
  v_mul_f32 v113, v113, v120
  v_mul_f32 v114, v114, v120
  v_mul_f32 v115, v115, v120
L_norescale:
  v_sub_f32 v72, v72, v116
  v_sub_f32 v73, v73, v116
  v_sub_f32 v74, v74, v116
  v_sub_f32 v75, v75, v116
  v_sub_f32 v76, v76, v116
  v_sub_f32 v77, v77, v116
  v_sub_f32 v78, v78, v116
  v_sub_f32 v79, v79, v116
  v_mul_f32 v72, s66, v72
  v_mul_f32 v73, s66, v73
  v_mul_f32 v74, s66, v74
  v_mul_f32 v75, s66, v75
  v_mul_f32 v76, s66, v76
  v_mul_f32 v77, s66, v77
  v_mul_f32 v78, s66, v78
  v_mul_f32 v79, s66, v79
  v_exp_f32 v72, v72
  v_exp_f32 v73, v73
  v_exp_f32 v74, v74
  v_exp_f32 v75, v75
  v_exp_f32 v76, v76
  v_exp_f32 v77, v77
  v_exp_f32 v78, v78
  v_exp_f32 v79, v79
  s_nop 0
  v_cvt_pk_bf16_f32 v80, v72, v73
  v_cvt_pk_bf16_f32 v81, v74, v75
  v_cvt_pk_bf16_f32 v82, v76, v77
  v_cvt_pk_bf16_f32 v83, v78, v79
  v_add_f32 v118, v72, v73
  v_add_f32 v119, v74, v75
  v_add_f32 v120, v76, v77
  v_add_f32 v121, v78, v79
  v_add_f32 v118, v118, v119
  v_add_f32 v120, v120, v121
  v_add_f32 v118, v118, v120
  v_add_f32 v117, v117, v118
L_dyn:
  s_cmp_eq_u32 s80, 0
  s_cbranch_scc1 L_sync
  v_readfirstlane_b32 s70, v126
  s_lshl_b32 s71, s70, 4
  s_or_b32 s71, s71, 15
  s_cmp_lt_u32 s70, 4
  s_cbranch_scc1 L_enc
  s_sub_u32 s70, s70, 4
  s_lshr_b32 s71, s70, 1
  s_add_u32 s71, s71, 4
  s_lshl_b32 s71, s71, 4
  s_and_b32 s75, s70, 1
  s_lshl_b32 s75, s75, 1
  s_lshl_b32 s75, 3, s75
  s_or_b32 s71, s71, s75
  s_cmp_lt_u32 s70, 16
  s_cbranch_scc1 L_enc
  s_sub_u32 s70, s70, 16
  s_min_u32 s70, s70, 16
  s_lshr_b32 s71, s70, 2
  s_add_u32 s71, s71, 12
  s_lshl_b32 s71, s71, 4
  s_and_b32 s75, s70, 3
  s_lshl_b32 s75, 1, s75
  s_or_b32 s71, s71, s75
L_enc:
  s_cmp_eq_u32 s74, 0
  s_cselect_b32 s70, 256, s71
  v_mov_b32 v118, s70
  v_mov_b32 v119, s31
  ds_write_b32 v119, v118
  s_waitcnt lgkmcnt(0)
L_sync:
  s_barrier
  v_mov_b32 v119, s31
  ds_read_b32 v119, v119
  s_xor_b32 s31, s31, 4
  s_waitcnt lgkmcnt(0)
  v_readfirstlane_b32 s28, v119
  s_and_b32 s75, s28, s82
  s_lshr_b32 s28, s28, 4
  s_cmp_lt_u32 s28, 16
  s_cbranch_scc1 L_more
  s_mov_b32 s75, 0
  s_branch L_next
L_more:
  s_cmp_eq_u32 s80, 0
  s_cbranch_scc1 L_next
  v_mov_b32 v126, 1
  s_mov_b64 exec, 1
  buffer_atomic_add v126, off, s[60:63], s9 sc0 sc1
  s_mov_b64 exec, -1
L_next:
  s_lshr_b32 s70, s28, 3
  s_add_u32 s70, s70, s26
  s_add_u32 s70, s70, 14
  s_and_b32 s70, s70, 15
  s_lshl_b32 s70, s70, 3
  s_and_b32 s71, s28, 7
  s_lshl_b32 s71, s71, 7
  s_add_u32 s70, s70, s71
  s_add_u32 s70, s70, s27
  s_lshl_b32 s71, s70, 6
  s_lshl_b32 s70, s70, 14
  s_cmp_eq_u32 s75, 0
  s_cselect_b32 s38, 0, 33554432
  s_cselect_b32 s70, 0, s70
  s_cmp_eq_u32 s30, 0
  s_cbranch_scc1 L_konly
  s_waitcnt vmcnt(14)
  v_cvt_f32_i32 v192, v192
  v_cvt_f32_i32 v193, v193
  v_cvt_f32_i32 v194, v194
  v_cvt_f32_i32 v195, v195
  v_cvt_f32_i32 v196, v196
  v_cvt_f32_i32 v197, v197
  v_cvt_f32_i32 v198, v198
  v_cvt_f32_i32 v199, v199
  v_pk_add_f32 v[192:193], v[192:193], v[32:33] op_sel_hi:[1,0] neg_lo:[0,1] neg_hi:[0,1]
  v_pk_add_f32 v[194:195], v[194:195], v[32:33] op_sel_hi:[1,0] neg_lo:[0,1] neg_hi:[0,1]
  v_pk_add_f32 v[196:197], v[196:197], v[34:35] op_sel_hi:[1,0] neg_lo:[0,1] neg_hi:[0,1]
  v_pk_add_f32 v[198:199], v[198:199], v[34:35] op_sel_hi:[1,0] neg_lo:[0,1] neg_hi:[0,1]
  v_cvt_pk_bf16_f32 v48, v192, v196
  v_cvt_pk_bf16_f32 v49, v193, v197
  v_cvt_pk_bf16_f32 v50, v194, v198
  v_cvt_pk_bf16_f32 v51, v195, v199
  buffer_load_dwordx4 v[128:131], v1, s[36:39], s70 offen offset:0 nt
  buffer_load_dwordx4 v[132:135], v1, s[36:39], s70 offen offset:256 nt
  v_dot2_f32_bf16 v52, v48, v33, 0
  v_dot2_f32_bf16 v53, v48, v35, 0
  v_dot2_f32_bf16 v54, v49, v33, 0
  v_dot2_f32_bf16 v55, v49, v35, 0
  v_dot2_f32_bf16 v56, v50, v33, 0
  v_dot2_f32_bf16 v57, v50, v35, 0
  v_dot2_f32_bf16 v58, v51, v33, 0
  v_dot2_f32_bf16 v59, v51, v35, 0
  v_cvt_pk_bf16_f32 v60, v52, v53
  v_cvt_pk_bf16_f32 v64, v54, v55
  v_cvt_pk_bf16_f32 v68, v56, v57
  v_cvt_pk_bf16_f32 v72, v58, v59
  s_waitcnt vmcnt(14)
  v_cvt_f32_i32 v200, v200
  v_cvt_f32_i32 v201, v201
  v_cvt_f32_i32 v202, v202
  v_cvt_f32_i32 v203, v203
  v_cvt_f32_i32 v204, v204
  v_cvt_f32_i32 v205, v205
  v_cvt_f32_i32 v206, v206
  v_cvt_f32_i32 v207, v207
  v_pk_add_f32 v[200:201], v[200:201], v[32:33] op_sel_hi:[1,0] neg_lo:[0,1] neg_hi:[0,1]
  v_pk_add_f32 v[202:203], v[202:203], v[32:33] op_sel_hi:[1,0] neg_lo:[0,1] neg_hi:[0,1]
  v_pk_add_f32 v[204:205], v[204:205], v[34:35] op_sel_hi:[1,0] neg_lo:[0,1] neg_hi:[0,1]
  v_pk_add_f32 v[206:207], v[206:207], v[34:35] op_sel_hi:[1,0] neg_lo:[0,1] neg_hi:[0,1]
  v_cvt_pk_bf16_f32 v48, v200, v204
  v_cvt_pk_bf16_f32 v49, v201, v205
  v_cvt_pk_bf16_f32 v50, v202, v206
  v_cvt_pk_bf16_f32 v51, v203, v207
  buffer_load_dwordx4 v[136:139], v1, s[36:39], s70 offen offset:512 nt
  buffer_load_dwordx4 v[140:143], v1, s[36:39], s70 offen offset:768 nt
  v_dot2_f32_bf16 v52, v48, v33, 0
  v_dot2_f32_bf16 v53, v48, v35, 0
  v_dot2_f32_bf16 v54, v49, v33, 0
  v_dot2_f32_bf16 v55, v49, v35, 0
  v_dot2_f32_bf16 v56, v50, v33, 0
  v_dot2_f32_bf16 v57, v50, v35, 0
  v_dot2_f32_bf16 v58, v51, v33, 0
  v_dot2_f32_bf16 v59, v51, v35, 0
  v_cvt_pk_bf16_f32 v192, v52, v53
  v_cvt_pk_bf16_f32 v196, v54, v55
  v_cvt_pk_bf16_f32 v200, v56, v57
  v_cvt_pk_bf16_f32 v204, v58, v59
  s_waitcnt vmcnt(14)
  v_cvt_f32_i32 v208, v208
  v_cvt_f32_i32 v209, v209
  v_cvt_f32_i32 v210, v210
  v_cvt_f32_i32 v211, v211
  v_cvt_f32_i32 v212, v212
  v_cvt_f32_i32 v213, v213
  v_cvt_f32_i32 v214, v214
  v_cvt_f32_i32 v215, v215
  v_pk_add_f32 v[208:209], v[208:209], v[36:37] op_sel_hi:[1,0] neg_lo:[0,1] neg_hi:[0,1]
  v_pk_add_f32 v[210:211], v[210:211], v[36:37] op_sel_hi:[1,0] neg_lo:[0,1] neg_hi:[0,1]
  v_pk_add_f32 v[212:213], v[212:213], v[38:39] op_sel_hi:[1,0] neg_lo:[0,1] neg_hi:[0,1]
  v_pk_add_f32 v[214:215], v[214:215], v[38:39] op_sel_hi:[1,0] neg_lo:[0,1] neg_hi:[0,1]
  v_cvt_pk_bf16_f32 v48, v208, v212
  v_cvt_pk_bf16_f32 v49, v209, v213
  v_cvt_pk_bf16_f32 v50, v210, v214
  v_cvt_pk_bf16_f32 v51, v211, v215
  buffer_load_dwordx4 v[144:147], v1, s[36:39], s70 offen offset:1024 nt
  buffer_load_dwordx4 v[148:151], v1, s[36:39], s70 offen offset:1280 nt
  v_dot2_f32_bf16 v52, v48, v37, 0
  v_dot2_f32_bf16 v53, v48, v39, 0
  v_dot2_f32_bf16 v54, v49, v37, 0
  v_dot2_f32_bf16 v55, v49, v39, 0
  v_dot2_f32_bf16 v56, v50, v37, 0
  v_dot2_f32_bf16 v57, v50, v39, 0
  v_dot2_f32_bf16 v58, v51, v37, 0
  v_dot2_f32_bf16 v59, v51, v39, 0
  v_cvt_pk_bf16_f32 v61, v52, v53
  v_cvt_pk_bf16_f32 v65, v54, v55
  v_cvt_pk_bf16_f32 v69, v56, v57
  v_cvt_pk_bf16_f32 v73, v58, v59
  s_waitcnt vmcnt(14)
  v_cvt_f32_i32 v216, v216
  v_cvt_f32_i32 v217, v217
  v_cvt_f32_i32 v218, v218
  v_cvt_f32_i32 v219, v219
  v_cvt_f32_i32 v220, v220
  v_cvt_f32_i32 v221, v221
  v_cvt_f32_i32 v222, v222
  v_cvt_f32_i32 v223, v223
  v_pk_add_f32 v[216:217], v[216:217], v[36:37] op_sel_hi:[1,0] neg_lo:[0,1] neg_hi:[0,1]
  v_pk_add_f32 v[218:219], v[218:219], v[36:37] op_sel_hi:[1,0] neg_lo:[0,1] neg_hi:[0,1]
  v_pk_add_f32 v[220:221], v[220:221], v[38:39] op_sel_hi:[1,0] neg_lo:[0,1] neg_hi:[0,1]
  v_pk_add_f32 v[222:223], v[222:223], v[38:39] op_sel_hi:[1,0] neg_lo:[0,1] neg_hi:[0,1]
  v_cvt_pk_bf16_f32 v48, v216, v220
  v_cvt_pk_bf16_f32 v49, v217, v221
  v_cvt_pk_bf16_f32 v50, v218, v222
  v_cvt_pk_bf16_f32 v51, v219, v223
  buffer_load_dwordx4 v[152:155], v1, s[36:39], s70 offen offset:1536 nt
  buffer_load_dwordx4 v[156:159], v1, s[36:39], s70 offen offset:1792 nt
  v_dot2_f32_bf16 v52, v48, v37, 0
  v_dot2_f32_bf16 v53, v48, v39, 0
  v_dot2_f32_bf16 v54, v49, v37, 0
  v_dot2_f32_bf16 v55, v49, v39, 0
  v_dot2_f32_bf16 v56, v50, v37, 0
  v_dot2_f32_bf16 v57, v50, v39, 0
  v_dot2_f32_bf16 v58, v51, v37, 0
  v_dot2_f32_bf16 v59, v51, v39, 0
  v_cvt_pk_bf16_f32 v193, v52, v53
  v_cvt_pk_bf16_f32 v197, v54, v55
  v_cvt_pk_bf16_f32 v201, v56, v57
  v_cvt_pk_bf16_f32 v205, v58, v59
  s_waitcnt vmcnt(14)
  v_cvt_f32_i32 v224, v224
  v_cvt_f32_i32 v225, v225
  v_cvt_f32_i32 v226, v226
  v_cvt_f32_i32 v227, v227
  v_cvt_f32_i32 v228, v228
  v_cvt_f32_i32 v229, v229
  v_cvt_f32_i32 v230, v230
  v_cvt_f32_i32 v231, v231
  v_pk_add_f32 v[224:225], v[224:225], v[40:41] op_sel_hi:[1,0] neg_lo:[0,1] neg_hi:[0,1]
  v_pk_add_f32 v[226:227], v[226:227], v[40:41] op_sel_hi:[1,0] neg_lo:[0,1] neg_hi:[0,1]
  v_pk_add_f32 v[228:229], v[228:229], v[42:43] op_sel_hi:[1,0] neg_lo:[0,1] neg_hi:[0,1]
  v_pk_add_f32 v[230:231], v[230:231], v[42:43] op_sel_hi:[1,0] neg_lo:[0,1] neg_hi:[0,1]
  v_cvt_pk_bf16_f32 v48, v224, v228
  v_cvt_pk_bf16_f32 v49, v225, v229
  v_cvt_pk_bf16_f32 v50, v226, v230
  v_cvt_pk_bf16_f32 v51, v227, v231
  buffer_load_dwordx4 v[160:163], v1, s[36:39], s70 offen offset:2048 nt
  buffer_load_dwordx4 v[164:167], v1, s[36:39], s70 offen offset:2304 nt
  v_dot2_f32_bf16 v52, v48, v41, 0
  v_dot2_f32_bf16 v53, v48, v43, 0
  v_dot2_f32_bf16 v54, v49, v41, 0
  v_dot2_f32_bf16 v55, v49, v43, 0
  v_dot2_f32_bf16 v56, v50, v41, 0
  v_dot2_f32_bf16 v57, v50, v43, 0
  v_dot2_f32_bf16 v58, v51, v41, 0
  v_dot2_f32_bf16 v59, v51, v43, 0
  v_cvt_pk_bf16_f32 v62, v52, v53
  v_cvt_pk_bf16_f32 v66, v54, v55
  v_cvt_pk_bf16_f32 v70, v56, v57
  v_cvt_pk_bf16_f32 v74, v58, v59
  s_waitcnt vmcnt(14)
  v_cvt_f32_i32 v232, v232
  v_cvt_f32_i32 v233, v233
  v_cvt_f32_i32 v234, v234
  v_cvt_f32_i32 v235, v235
  v_cvt_f32_i32 v236, v236
  v_cvt_f32_i32 v237, v237
  v_cvt_f32_i32 v238, v238
  v_cvt_f32_i32 v239, v239
  v_pk_add_f32 v[232:233], v[232:233], v[40:41] op_sel_hi:[1,0] neg_lo:[0,1] neg_hi:[0,1]
  v_pk_add_f32 v[234:235], v[234:235], v[40:41] op_sel_hi:[1,0] neg_lo:[0,1] neg_hi:[0,1]
  v_pk_add_f32 v[236:237], v[236:237], v[42:43] op_sel_hi:[1,0] neg_lo:[0,1] neg_hi:[0,1]
  v_pk_add_f32 v[238:239], v[238:239], v[42:43] op_sel_hi:[1,0] neg_lo:[0,1] neg_hi:[0,1]
  v_cvt_pk_bf16_f32 v48, v232, v236
  v_cvt_pk_bf16_f32 v49, v233, v237
  v_cvt_pk_bf16_f32 v50, v234, v238
  v_cvt_pk_bf16_f32 v51, v235, v239
  buffer_load_dwordx4 v[168:171], v1, s[36:39], s70 offen offset:2560 nt
  buffer_load_dwordx4 v[172:175], v1, s[36:39], s70 offen offset:2816 nt
  v_dot2_f32_bf16 v52, v48, v41, 0
  v_dot2_f32_bf16 v53, v48, v43, 0
  v_dot2_f32_bf16 v54, v49, v41, 0
  v_dot2_f32_bf16 v55, v49, v43, 0
  v_dot2_f32_bf16 v56, v50, v41, 0
  v_dot2_f32_bf16 v57, v50, v43, 0
  v_dot2_f32_bf16 v58, v51, v41, 0
  v_dot2_f32_bf16 v59, v51, v43, 0
  v_cvt_pk_bf16_f32 v194, v52, v53
  v_cvt_pk_bf16_f32 v198, v54, v55
  v_cvt_pk_bf16_f32 v202, v56, v57
  v_cvt_pk_bf16_f32 v206, v58, v59
  s_waitcnt vmcnt(14)
  v_cvt_f32_i32 v240, v240
  v_cvt_f32_i32 v241, v241
  v_cvt_f32_i32 v242, v242
  v_cvt_f32_i32 v243, v243
  v_cvt_f32_i32 v244, v244
  v_cvt_f32_i32 v245, v245
  v_cvt_f32_i32 v246, v246
  v_cvt_f32_i32 v247, v247
  v_pk_add_f32 v[240:241], v[240:241], v[44:45] op_sel_hi:[1,0] neg_lo:[0,1] neg_hi:[0,1]
  v_pk_add_f32 v[242:243], v[242:243], v[44:45] op_sel_hi:[1,0] neg_lo:[0,1] neg_hi:[0,1]
  v_pk_add_f32 v[244:245], v[244:245], v[46:47] op_sel_hi:[1,0] neg_lo:[0,1] neg_hi:[0,1]
  v_pk_add_f32 v[246:247], v[246:247], v[46:47] op_sel_hi:[1,0] neg_lo:[0,1] neg_hi:[0,1]
  v_cvt_pk_bf16_f32 v48, v240, v244
  v_cvt_pk_bf16_f32 v49, v241, v245
  v_cvt_pk_bf16_f32 v50, v242, v246
  v_cvt_pk_bf16_f32 v51, v243, v247
  buffer_load_dwordx4 v[176:179], v1, s[36:39], s70 offen offset:3072 nt
  buffer_load_dwordx4 v[180:183], v1, s[36:39], s70 offen offset:3328 nt
  v_dot2_f32_bf16 v52, v48, v45, 0
  v_dot2_f32_bf16 v53, v48, v47, 0
  v_dot2_f32_bf16 v54, v49, v45, 0
  v_dot2_f32_bf16 v55, v49, v47, 0
  v_dot2_f32_bf16 v56, v50, v45, 0
  v_dot2_f32_bf16 v57, v50, v47, 0
  v_dot2_f32_bf16 v58, v51, v45, 0
  v_dot2_f32_bf16 v59, v51, v47, 0
  v_cvt_pk_bf16_f32 v63, v52, v53
  v_cvt_pk_bf16_f32 v67, v54, v55
  v_cvt_pk_bf16_f32 v71, v56, v57
  v_cvt_pk_bf16_f32 v75, v58, v59
  s_nop 1
  v_mfma_f32_16x16x32_bf16 v[84:87], v[80:83], v[60:63], v[84:87]
  v_mfma_f32_16x16x32_bf16 v[88:91], v[80:83], v[64:67], v[88:91]
  v_mfma_f32_16x16x32_bf16 v[92:95], v[80:83], v[68:71], v[92:95]
  v_mfma_f32_16x16x32_bf16 v[96:99], v[80:83], v[72:75], v[96:99]
  s_waitcnt vmcnt(14)
  v_cvt_f32_i32 v248, v248
  v_cvt_f32_i32 v249, v249
  v_cvt_f32_i32 v250, v250
  v_cvt_f32_i32 v251, v251
  v_cvt_f32_i32 v252, v252
  v_cvt_f32_i32 v253, v253
  v_cvt_f32_i32 v254, v254
  v_cvt_f32_i32 v255, v255
  v_pk_add_f32 v[248:249], v[248:249], v[44:45] op_sel_hi:[1,0] neg_lo:[0,1] neg_hi:[0,1]
  v_pk_add_f32 v[250:251], v[250:251], v[44:45] op_sel_hi:[1,0] neg_lo:[0,1] neg_hi:[0,1]
  v_pk_add_f32 v[252:253], v[252:253], v[46:47] op_sel_hi:[1,0] neg_lo:[0,1] neg_hi:[0,1]
  v_pk_add_f32 v[254:255], v[254:255], v[46:47] op_sel_hi:[1,0] neg_lo:[0,1] neg_hi:[0,1]
  v_cvt_pk_bf16_f32 v48, v248, v252
  v_cvt_pk_bf16_f32 v49, v249, v253
  v_cvt_pk_bf16_f32 v50, v250, v254
  v_cvt_pk_bf16_f32 v51, v251, v255
  buffer_load_dwordx4 v[184:187], v1, s[36:39], s70 offen offset:3584 nt
  buffer_load_dwordx4 v[188:191], v1, s[36:39], s70 offen offset:3840 nt
  v_dot2_f32_bf16 v52, v48, v45, 0
  v_dot2_f32_bf16 v53, v48, v47, 0
  v_dot2_f32_bf16 v54, v49, v45, 0
  v_dot2_f32_bf16 v55, v49, v47, 0
  v_dot2_f32_bf16 v56, v50, v45, 0
  v_dot2_f32_bf16 v57, v50, v47, 0
  v_dot2_f32_bf16 v58, v51, v45, 0
  v_dot2_f32_bf16 v59, v51, v47, 0
  v_cvt_pk_bf16_f32 v195, v52, v53
  v_cvt_pk_bf16_f32 v199, v54, v55
  v_cvt_pk_bf16_f32 v203, v56, v57
  v_cvt_pk_bf16_f32 v207, v58, v59
  s_nop 1
  v_mfma_f32_16x16x32_bf16 v[100:103], v[80:83], v[192:195], v[100:103]
  v_mfma_f32_16x16x32_bf16 v[104:107], v[80:83], v[196:199], v[104:107]
  v_mfma_f32_16x16x32_bf16 v[108:111], v[80:83], v[200:203], v[108:111]
  v_mfma_f32_16x16x32_bf16 v[112:115], v[80:83], v[204:207], v[112:115]
L_step:
  s_mov_b32 s72, s70
  s_mov_b32 s73, s71
  s_mov_b32 s30, s75
  s_add_u32 s34, s34, 1
  s_cmp_lt_u32 s28, 16
  s_cbranch_scc1 L_loop
  s_branch L_epi
L_idle:
  s_waitcnt vmcnt(0)
  s_branch L_dyn
L_konly:
  s_cmp_eq_u32 s75, 0
  s_cbranch_scc1 L_step
  buffer_load_dwordx4 v[128:131], v1, s[36:39], s70 offen offset:0 nt
  buffer_load_dwordx4 v[132:135], v1, s[36:39], s70 offen offset:256 nt
  buffer_load_dwordx4 v[136:139], v1, s[36:39], s70 offen offset:512 nt
  buffer_load_dwordx4 v[140:143], v1, s[36:39], s70 offen offset:768 nt
  buffer_load_dwordx4 v[144:147], v1, s[36:39], s70 offen offset:1024 nt
  buffer_load_dwordx4 v[148:151], v1, s[36:39], s70 offen offset:1280 nt
  buffer_load_dwordx4 v[152:155], v1, s[36:39], s70 offen offset:1536 nt
  buffer_load_dwordx4 v[156:159], v1, s[36:39], s70 offen offset:1792 nt
  buffer_load_dwordx4 v[160:163], v1, s[36:39], s70 offen offset:2048 nt
  buffer_load_dwordx4 v[164:167], v1, s[36:39], s70 offen offset:2304 nt
  buffer_load_dwordx4 v[168:171], v1, s[36:39], s70 offen offset:2560 nt
  buffer_load_dwordx4 v[172:175], v1, s[36:39], s70 offen offset:2816 nt
  buffer_load_dwordx4 v[176:179], v1, s[36:39], s70 offen offset:3072 nt
  buffer_load_dwordx4 v[180:183], v1, s[36:39], s70 offen offset:3328 nt
  buffer_load_dwordx4 v[184:187], v1, s[36:39], s70 offen offset:3584 nt
  buffer_load_dwordx4 v[188:191], v1, s[36:39], s70 offen offset:3840 nt
  s_branch L_step
L_epi:
  v_mov_b32 v119, v117
  s_nop 1
  v_permlane16_swap_b32 v117, v119
  v_add_f32 v117, v117, v119
  v_mov_b32 v119, v117
  s_nop 1
  v_permlane32_swap_b32 v117, v119
  v_add_f32 v117, v117, v119
  v_readfirstlane_b32 s49, v127
  v_readlane_b32 s70, v116, 0
  v_readlane_b32 s71, v116, 4
  v_readlane_b32 s72, v117, 0
  v_readlane_b32 s73, v117, 4
  v_lshlrev_b32 v122, 4, v0
  v_lshrrev_b32 v123, 1, v0
  v_and_b32 v123, 8, v123
  s_cmp_eq_u32 s49, 15
  s_cselect_b32 s69, s80, 0
  s_xor_b32 s4, s83, 2048
  s_xor_b32 s5, s83, 4096
  s_xor_b32 s6, s83, 6144
  s_xor_b32 s7, s83, 8192
  s_xor_b32 s8, s83, 10240
  s_xor_b32 s9, s83, 12288
  s_xor_b32 s10, s83, 14336
  s_xor_b32 s11, s83, 16384
  s_xor_b32 s12, s83, 18432
  s_xor_b32 s13, s83, 20480
  s_xor_b32 s14, s83, 22528
  s_xor_b32 s15, s83, 24576
  s_xor_b32 s16, s83, 26624
  s_xor_b32 s17, s83, 28672
  s_xor_b32 s18, s83, 30720
  s_cmp_eq_u32 s69, 0
  s_cbranch_scc1 L_nopoll
  s_waitcnt vmcnt(0)
  buffer_load_dwordx4 v[128:131], v122, s[60:63], s4 offen sc1
  buffer_load_dwordx2 v[132:133], v123, s[60:63], s4 offen offset:1024 sc1
  buffer_load_dwordx4 v[136:139], v122, s[60:63], s5 offen sc1
  buffer_load_dwordx2 v[140:141], v123, s[60:63], s5 offen offset:1024 sc1
  buffer_load_dwordx4 v[144:147], v122, s[60:63], s6 offen sc1
  buffer_load_dwordx2 v[148:149], v123, s[60:63], s6 offen offset:1024 sc1
  buffer_load_dwordx4 v[152:155], v122, s[60:63], s7 offen sc1
  buffer_load_dwordx2 v[156:157], v123, s[60:63], s7 offen offset:1024 sc1
  buffer_load_dwordx4 v[160:163], v122, s[60:63], s8 offen sc1
  buffer_load_dwordx2 v[164:165], v123, s[60:63], s8 offen offset:1024 sc1
  buffer_load_dwordx4 v[168:171], v122, s[60:63], s9 offen sc1
  buffer_load_dwordx2 v[172:173], v123, s[60:63], s9 offen offset:1024 sc1
  buffer_load_dwordx4 v[176:179], v122, s[60:63], s10 offen sc1
  buffer_load_dwordx2 v[180:181], v123, s[60:63], s10 offen offset:1024 sc1
  buffer_load_dwordx4 v[184:187], v122, s[60:63], s11 offen sc1
  buffer_load_dwordx2 v[188:189], v123, s[60:63], s11 offen offset:1024 sc1
  buffer_load_dwordx4 v[192:195], v122, s[60:63], s12 offen sc1
  buffer_load_dwordx2 v[196:197], v123, s[60:63], s12 offen offset:1024 sc1
  buffer_load_dwordx4 v[200:203], v122, s[60:63], s13 offen sc1
  buffer_load_dwordx2 v[204:205], v123, s[60:63], s13 offen offset:1024 sc1
  buffer_load_dwordx4 v[208:211], v122, s[60:63], s14 offen sc1
  buffer_load_dwordx2 v[212:213], v123, s[60:63], s14 offen offset:1024 sc1
  buffer_load_dwordx4 v[216:219], v122, s[60:63], s15 offen sc1
  buffer_load_dwordx2 v[220:221], v123, s[60:63], s15 offen offset:1024 sc1
  buffer_load_dwordx4 v[224:227], v122, s[60:63], s16 offen sc1
  buffer_load_dwordx2 v[228:229], v123, s[60:63], s16 offen offset:1024 sc1
  buffer_load_dwordx4 v[232:235], v122, s[60:63], s17 offen sc1
  buffer_load_dwordx2 v[236:237], v123, s[60:63], s17 offen offset:1024 sc1
  buffer_load_dwordx4 v[240:243], v122, s[60:63], s18 offen sc1
  buffer_load_dwordx2 v[244:245], v123, s[60:63], s18 offen offset:1024 sc1
L_nopoll:
  v_mov_b32 v118, s70
  v_mov_b32 v119, s71
  v_mov_b32 v120, s72
  v_mov_b32 v121, s73
  v_cndmask_b32 v56, v118, v119, s[64:65]
  v_cndmask_b32 v57, v120, v121, s[64:65]
  s_mov_b32 s74, 0
  s_mov_b32 s75, -1
  s_mul_i32 s70, s3, 3584
  v_add_u32 v124, s70, v122
  v_lshl_add_u32 v118, v0, 3, s70
  s_nop 4
  v_cndmask_b32 v52, v84, v100, s[74:75]
  v_cndmask_b32 v53, v88, v104, s[74:75]
  v_cndmask_b32 v54, v92, v108, s[74:75]
  v_cndmask_b32 v55, v96, v112, s[74:75]
  ds_write_b128 v124, v[52:55]
  ds_write_b64 v118, v[56:57] offset:1024
  s_waitcnt lgkmcnt(0)
  s_barrier
  s_cmp_eq_u32 s80, 0
  s_cbranch_scc1 L_main_end
  ds_read_b128 v[88:91], v124 offset:3584
  ds_read_b64 v[34:35], v118 offset:4608
  ds_read_b128 v[92:95], v124 offset:7168
  ds_read_b64 v[36:37], v118 offset:8192
  ds_read_b128 v[96:99], v124 offset:10752
  ds_read_b64 v[38:39], v118 offset:11776
  ds_read_b128 v[100:103], v124 offset:14336
  ds_read_b64 v[40:41], v118 offset:15360
  ds_read_b128 v[104:107], v124 offset:17920
  ds_read_b64 v[42:43], v118 offset:18944
  ds_read_b128 v[108:111], v124 offset:21504
  ds_read_b64 v[44:45], v118 offset:22528
  ds_read_b128 v[112:115], v124 offset:25088
  ds_read_b64 v[46:47], v118 offset:26112
  s_waitcnt lgkmcnt(0)
  v_max3_f32 v118, v56, v34, v36
  v_max3_f32 v118, v118, v38, v40
  v_max3_f32 v118, v118, v42, v44
  v_max_f32 v118, v118, v46
  v_sub_f32 v56, v56, v118
  v_sub_f32 v34, v34, v118
  v_sub_f32 v36, v36, v118
  v_sub_f32 v38, v38, v118
  v_sub_f32 v40, v40, v118
  v_sub_f32 v42, v42, v118
  v_sub_f32 v44, v44, v118
  v_sub_f32 v46, v46, v118
  v_mul_f32 v56, s66, v56
  v_mul_f32 v34, s66, v34
  v_mul_f32 v36, s66, v36
  v_mul_f32 v38, s66, v38
  v_mul_f32 v40, s66, v40
  v_mul_f32 v42, s66, v42
  v_mul_f32 v44, s66, v44
  v_mul_f32 v46, s66, v46
  v_exp_f32 v56, v56
  v_exp_f32 v34, v34
  v_exp_f32 v36, v36
  v_exp_f32 v38, v38
  v_exp_f32 v40, v40
  v_exp_f32 v42, v42
  v_exp_f32 v44, v44
  v_exp_f32 v46, v46
  s_nop 0
  v_mul_f32 v52, v52, v56
  v_mul_f32 v53, v53, v56
  v_mul_f32 v54, v54, v56
  v_mul_f32 v55, v55, v56
  v_mul_f32 v57, v57, v56
  v_fmac_f32 v52, v88, v34
  v_fmac_f32 v53, v89, v34
  v_fmac_f32 v54, v90, v34
  v_fmac_f32 v55, v91, v34
  v_fmac_f32 v57, v35, v34
  v_fmac_f32 v52, v92, v36
  v_fmac_f32 v53, v93, v36
  v_fmac_f32 v54, v94, v36
  v_fmac_f32 v55, v95, v36
  v_fmac_f32 v57, v37, v36
  v_fmac_f32 v52, v96, v38
  v_fmac_f32 v53, v97, v38
  v_fmac_f32 v54, v98, v38
  v_fmac_f32 v55, v99, v38
  v_fmac_f32 v57, v39, v38
  v_fmac_f32 v52, v100, v40
  v_fmac_f32 v53, v101, v40
  v_fmac_f32 v54, v102, v40
  v_fmac_f32 v55, v103, v40
  v_fmac_f32 v57, v41, v40
  v_fmac_f32 v52, v104, v42
  v_fmac_f32 v53, v105, v42
  v_fmac_f32 v54, v106, v42
  v_fmac_f32 v55, v107, v42
  v_fmac_f32 v57, v43, v42
  v_fmac_f32 v52, v108, v44
  v_fmac_f32 v53, v109, v44
  v_fmac_f32 v54, v110, v44
  v_fmac_f32 v55, v111, v44
  v_fmac_f32 v57, v45, v44
  v_fmac_f32 v52, v112, v46
  v_fmac_f32 v53, v113, v46
  v_fmac_f32 v54, v114, v46
  v_fmac_f32 v55, v115, v46
  v_fmac_f32 v57, v47, v46
  v_mov_b32 v56, v118
  s_cmp_eq_u32 s69, 0
  s_cbranch_scc0 L_comb
  v_min_u32 v52, -2, v52
  v_min_u32 v53, -2, v53
  v_min_u32 v54, -2, v54
  v_min_u32 v55, -2, v55
  v_min_u32 v56, -2, v56
  v_min_u32 v57, -2, v57
  buffer_store_dwordx4 v[52:55], v122, s[60:63], s83 offen sc1
  s_mov_b64 exec, 0x10001
  buffer_store_dwordx2 v[56:57], v123, s[60:63], s83 offen offset:1024 sc1
  s_endpgm
L_repoll:
  s_add_u32 s69, s69, 1
  s_cmp_gt_u32 s69, 0x100000
  s_cbranch_scc1 L_main_end
  buffer_load_dwordx4 v[128:131], v122, s[60:63], s4 offen sc1
  buffer_load_dwordx2 v[132:133], v123, s[60:63], s4 offen offset:1024 sc1
  buffer_load_dwordx4 v[136:139], v122, s[60:63], s5 offen sc1
  buffer_load_dwordx2 v[140:141], v123, s[60:63], s5 offen offset:1024 sc1
  buffer_load_dwordx4 v[144:147], v122, s[60:63], s6 offen sc1
  buffer_load_dwordx2 v[148:149], v123, s[60:63], s6 offen offset:1024 sc1
  buffer_load_dwordx4 v[152:155], v122, s[60:63], s7 offen sc1
  buffer_load_dwordx2 v[156:157], v123, s[60:63], s7 offen offset:1024 sc1
  buffer_load_dwordx4 v[160:163], v122, s[60:63], s8 offen sc1
  buffer_load_dwordx2 v[164:165], v123, s[60:63], s8 offen offset:1024 sc1
  buffer_load_dwordx4 v[168:171], v122, s[60:63], s9 offen sc1
  buffer_load_dwordx2 v[172:173], v123, s[60:63], s9 offen offset:1024 sc1
  buffer_load_dwordx4 v[176:179], v122, s[60:63], s10 offen sc1
  buffer_load_dwordx2 v[180:181], v123, s[60:63], s10 offen offset:1024 sc1
  buffer_load_dwordx4 v[184:187], v122, s[60:63], s11 offen sc1
  buffer_load_dwordx2 v[188:189], v123, s[60:63], s11 offen offset:1024 sc1
  buffer_load_dwordx4 v[192:195], v122, s[60:63], s12 offen sc1
  buffer_load_dwordx2 v[196:197], v123, s[60:63], s12 offen offset:1024 sc1
  buffer_load_dwordx4 v[200:203], v122, s[60:63], s13 offen sc1
  buffer_load_dwordx2 v[204:205], v123, s[60:63], s13 offen offset:1024 sc1
  buffer_load_dwordx4 v[208:211], v122, s[60:63], s14 offen sc1
  buffer_load_dwordx2 v[212:213], v123, s[60:63], s14 offen offset:1024 sc1
  buffer_load_dwordx4 v[216:219], v122, s[60:63], s15 offen sc1
  buffer_load_dwordx2 v[220:221], v123, s[60:63], s15 offen offset:1024 sc1
  buffer_load_dwordx4 v[224:227], v122, s[60:63], s16 offen sc1
  buffer_load_dwordx2 v[228:229], v123, s[60:63], s16 offen offset:1024 sc1
  buffer_load_dwordx4 v[232:235], v122, s[60:63], s17 offen sc1
  buffer_load_dwordx2 v[236:237], v123, s[60:63], s17 offen offset:1024 sc1
  buffer_load_dwordx4 v[240:243], v122, s[60:63], s18 offen sc1
  buffer_load_dwordx2 v[244:245], v123, s[60:63], s18 offen offset:1024 sc1
L_comb:
  s_waitcnt vmcnt(0)
  v_max3_u32 v118, v128, v129, v130
  v_max3_u32 v119, v131, v132, v133
  v_max3_u32 v118, v118, v136, v137
  v_max3_u32 v119, v119, v138, v139
  v_max3_u32 v118, v118, v140, v141
  v_max3_u32 v119, v119, v144, v145
  v_max3_u32 v118, v118, v146, v147
  v_max3_u32 v119, v119, v148, v149
  v_max3_u32 v118, v118, v152, v153
  v_max3_u32 v119, v119, v154, v155
  v_max3_u32 v118, v118, v156, v157
  v_max3_u32 v119, v119, v160, v161
  v_max3_u32 v118, v118, v162, v163
  v_max3_u32 v119, v119, v164, v165
  v_max3_u32 v118, v118, v168, v169
  v_max3_u32 v119, v119, v170, v171
  v_max3_u32 v118, v118, v172, v173
  v_max3_u32 v119, v119, v176, v177
  v_max3_u32 v118, v118, v178, v179
  v_max3_u32 v119, v119, v180, v181
  v_max3_u32 v118, v118, v184, v185
  v_max3_u32 v119, v119, v186, v187
  v_max3_u32 v118, v118, v188, v189
  v_max3_u32 v119, v119, v192, v193
  v_max3_u32 v118, v118, v194, v195
  v_max3_u32 v119, v119, v196, v197
  v_max3_u32 v118, v118, v200, v201
  v_max3_u32 v119, v119, v202, v203
  v_max3_u32 v118, v118, v204, v205
  v_max3_u32 v119, v119, v208, v209
  v_max3_u32 v118, v118, v210, v211
  v_max3_u32 v119, v119, v212, v213
  v_max3_u32 v118, v118, v216, v217
  v_max3_u32 v119, v119, v218, v219
  v_max3_u32 v118, v118, v220, v221
  v_max3_u32 v119, v119, v224, v225
  v_max3_u32 v118, v118, v226, v227
  v_max3_u32 v119, v119, v228, v229
  v_max3_u32 v118, v118, v232, v233
  v_max3_u32 v119, v119, v234, v235
  v_max3_u32 v118, v118, v236, v237
  v_max3_u32 v119, v119, v240, v241
  v_max3_u32 v118, v118, v242, v243
  v_max3_u32 v119, v119, v244, v245
  v_max_u32 v118, v118, v119
  v_cmp_eq_u32 vcc, -1, v118
  s_cbranch_vccnz L_repoll
  v_max3_f32 v118, v56, v132, v140
  v_max3_f32 v118, v118, v148, v156
  v_max3_f32 v118, v118, v164, v172
  v_max3_f32 v118, v118, v180, v188
  v_max3_f32 v118, v118, v196, v204
  v_max3_f32 v118, v118, v212, v220
  v_max3_f32 v118, v118, v228, v236
  v_max_f32 v118, v118, v244
  v_sub_f32 v56, v56, v118
  v_sub_f32 v132, v132, v118
  v_sub_f32 v140, v140, v118
  v_sub_f32 v148, v148, v118
  v_sub_f32 v156, v156, v118
  v_sub_f32 v164, v164, v118
  v_sub_f32 v172, v172, v118
  v_sub_f32 v180, v180, v118
  v_sub_f32 v188, v188, v118
  v_sub_f32 v196, v196, v118
  v_sub_f32 v204, v204, v118
  v_sub_f32 v212, v212, v118
  v_sub_f32 v220, v220, v118
  v_sub_f32 v228, v228, v118
  v_sub_f32 v236, v236, v118
  v_sub_f32 v244, v244, v118
  v_mul_f32 v56, s66, v56
  v_mul_f32 v132, s66, v132
  v_mul_f32 v140, s66, v140
  v_mul_f32 v148, s66, v148
  v_mul_f32 v156, s66, v156
  v_mul_f32 v164, s66, v164
  v_mul_f32 v172, s66, v172
  v_mul_f32 v180, s66, v180
  v_mul_f32 v188, s66, v188
  v_mul_f32 v196, s66, v196
  v_mul_f32 v204, s66, v204
  v_mul_f32 v212, s66, v212
  v_mul_f32 v220, s66, v220
  v_mul_f32 v228, s66, v228
  v_mul_f32 v236, s66, v236
  v_mul_f32 v244, s66, v244
  v_exp_f32 v56, v56
  v_exp_f32 v132, v132
  v_exp_f32 v140, v140
  v_exp_f32 v148, v148
  v_exp_f32 v156, v156
  v_exp_f32 v164, v164
  v_exp_f32 v172, v172
  v_exp_f32 v180, v180
  v_exp_f32 v188, v188
  v_exp_f32 v196, v196
  v_exp_f32 v204, v204
  v_exp_f32 v212, v212
  v_exp_f32 v220, v220
  v_exp_f32 v228, v228
  v_exp_f32 v236, v236
  v_exp_f32 v244, v244
  s_nop 0
  v_mul_f32 v52, v52, v56
  v_mul_f32 v53, v53, v56
  v_mul_f32 v54, v54, v56
  v_mul_f32 v55, v55, v56
  v_mul_f32 v57, v57, v56
  v_fmac_f32 v52, v128, v132
  v_fmac_f32 v53, v129, v132
  v_fmac_f32 v54, v130, v132
  v_fmac_f32 v55, v131, v132
  v_fmac_f32 v57, v133, v132
  v_fmac_f32 v52, v136, v140
  v_fmac_f32 v53, v137, v140
  v_fmac_f32 v54, v138, v140
  v_fmac_f32 v55, v139, v140
  v_fmac_f32 v57, v141, v140
  v_fmac_f32 v52, v144, v148
  v_fmac_f32 v53, v145, v148
  v_fmac_f32 v54, v146, v148
  v_fmac_f32 v55, v147, v148
  v_fmac_f32 v57, v149, v148
  v_fmac_f32 v52, v152, v156
  v_fmac_f32 v53, v153, v156
  v_fmac_f32 v54, v154, v156
  v_fmac_f32 v55, v155, v156
  v_fmac_f32 v57, v157, v156
  v_fmac_f32 v52, v160, v164
  v_fmac_f32 v53, v161, v164
  v_fmac_f32 v54, v162, v164
  v_fmac_f32 v55, v163, v164
  v_fmac_f32 v57, v165, v164
  v_fmac_f32 v52, v168, v172
  v_fmac_f32 v53, v169, v172
  v_fmac_f32 v54, v170, v172
  v_fmac_f32 v55, v171, v172
  v_fmac_f32 v57, v173, v172
  v_fmac_f32 v52, v176, v180
  v_fmac_f32 v53, v177, v180
  v_fmac_f32 v54, v178, v180
  v_fmac_f32 v55, v179, v180
  v_fmac_f32 v57, v181, v180
  v_fmac_f32 v52, v184, v188
  v_fmac_f32 v53, v185, v188
  v_fmac_f32 v54, v186, v188
  v_fmac_f32 v55, v187, v188
  v_fmac_f32 v57, v189, v188
  v_fmac_f32 v52, v192, v196
  v_fmac_f32 v53, v193, v196
  v_fmac_f32 v54, v194, v196
  v_fmac_f32 v55, v195, v196
  v_fmac_f32 v57, v197, v196
  v_fmac_f32 v52, v200, v204
  v_fmac_f32 v53, v201, v204
  v_fmac_f32 v54, v202, v204
  v_fmac_f32 v55, v203, v204
  v_fmac_f32 v57, v205, v204
  v_fmac_f32 v52, v208, v212
  v_fmac_f32 v53, v209, v212
  v_fmac_f32 v54, v210, v212
  v_fmac_f32 v55, v211, v212
  v_fmac_f32 v57, v213, v212
  v_fmac_f32 v52, v216, v220
  v_fmac_f32 v53, v217, v220
  v_fmac_f32 v54, v218, v220
  v_fmac_f32 v55, v219, v220
  v_fmac_f32 v57, v221, v220
  v_fmac_f32 v52, v224, v228
  v_fmac_f32 v53, v225, v228
  v_fmac_f32 v54, v226, v228
  v_fmac_f32 v55, v227, v228
  v_fmac_f32 v57, v229, v228
  v_fmac_f32 v52, v232, v236
  v_fmac_f32 v53, v233, v236
  v_fmac_f32 v54, v234, v236
  v_fmac_f32 v55, v235, v236
  v_fmac_f32 v57, v237, v236
  v_fmac_f32 v52, v240, v244
  v_fmac_f32 v53, v241, v244
  v_fmac_f32 v54, v242, v244
  v_fmac_f32 v55, v243, v244
  v_fmac_f32 v57, v245, v244
  v_mov_b32 v56, v118
  v_rcp_f32 v119, v57
  v_bfe_u32 v120, v0, 4, 1
  v_lshrrev_b32 v121, 5, v0
  v_and_b32 v122, 15, v0
  v_fma_f32 v118, -v57, v119, 1.0
  v_fma_f32 v119, v118, v119, v119
  v_lshlrev_b32 v120, 8, v120
  v_lshl_add_u32 v120, v121, 7, v120
  v_lshl_add_u32 v120, v122, 3, v120
  v_mul_f32 v52, v52, v119
  v_mul_f32 v53, v53, v119
  v_mul_f32 v54, v54, v119
  v_mul_f32 v55, v55, v119
  v_cvt_pk_bf16_f32 v52, v52, v53
  v_cvt_pk_bf16_f32 v53, v54, v55
  s_lshl_b32 s70, s26, 9
  buffer_store_dwordx2 v[52:53], v120, s[92:95], s70 offen
L_main_end:
  s_endpgm
.section .rodata,"a"
.p2align 6
.amdhsa_kernel standalone__kv_cache_quant_int4_int2_kv_with_per_channel_or_per_token_scales__decode_kernel
  .amdhsa_next_free_vgpr 256
  .amdhsa_next_free_sgpr 96
  .amdhsa_accum_offset 256
  .amdhsa_group_segment_fixed_size 0
  .amdhsa_kernarg_size 80
  .amdhsa_user_sgpr_count 2
  .amdhsa_user_sgpr_kernarg_segment_ptr 1
  .amdhsa_system_sgpr_workgroup_id_x 1
  .amdhsa_float_denorm_mode_32 3
.end_amdhsa_kernel
```
